```python
import torch

def _softmax(x, axis=-1):
    return torch.softmax(x, dim=axis)
def _gelu(x):
    return torch.nn.functional.gelu(x, approximate="tanh")
def _silu(x):
    return torch.nn.functional.silu(x)
def _sigmoid(x):
    return torch.sigmoid(x)
def _layernorm(x, axis=-1, eps=1e-5):
    m = x.mean(dim=axis, keepdim=True)
    v = x.var(dim=axis, keepdim=True, unbiased=False)
    return (x - m) / torch.sqrt(v + eps)
def _scatter_add(tgt, idx, src, axis=0):
    return tgt.clone().index_add_(axis, idx, src)
def _segment_sum(src, seg, n):
    out = torch.zeros((n,) + src.shape[1:], dtype=src.dtype)
    return out.index_add_(0, seg, src)
def _pad(x, pw):
    flat = tuple(v for pair in reversed(pw) for v in pair)
    return torch.nn.functional.pad(x, flat)

kernel_name = 'concat_heads__spectral_fnet__linear_kernel_hedgehog__prompt'

def setup_inputs():

    _w = (lambda a: (lambda t: t.to(torch.bfloat16) if t.is_floating_point() else t)(torch.as_tensor(a)))
    def _A_setup():
        B, S, D = 1, 2048, 448
        ns = torch.arange(S)[:, None] * torch.arange(S)[None, :]
        nd = torch.arange(D)[:, None] * torch.arange(D)[None, :]
        Ws_re = torch.cos(-2.0 * torch.pi * ns / S).to(float)
        Ws_im = torch.sin(-2.0 * torch.pi * ns / S).to(float)
        Wd_re = torch.cos(-2.0 * torch.pi * nd / D).to(float)
        Wd_im = torch.sin(-2.0 * torch.pi * nd / D).to(float)
        return {
            "x": _w((lambda *s: torch.randn(*s, dtype=torch.bfloat16) * 0.05)(B, S, D)),
            "dft_seq_re": _w(Ws_re),
            "dft_seq_im": _w(Ws_im),
            "dft_hid_re": _w(Wd_re),
            "dft_hid_im": _w(Wd_im),
        }
    _A_in = _A_setup()

    def _B_setup():
        B, S, D, H = 1, 2048, 448, 16
        Dh = D // H
        return {
            "x": _w((lambda *s: torch.randn(*s, dtype=torch.bfloat16) * 0.2)(B, S, D)),
            "wqkv": _w((lambda *s: torch.randn(*s, dtype=torch.bfloat16) * 1.6)(D, 3 * D)),
            "w_phi": _w((lambda *s: torch.randn(*s, dtype=torch.bfloat16) * 1.6)(H, Dh, Dh) * (Dh ** -0.5)),
            "wo": _w((lambda *s: torch.randn(*s, dtype=torch.bfloat16) * 0.8)(D, D)),
        }
    _B_in = _B_setup()

    return {
        "A_x": _A_in["x"],
        "A_dft_seq_re": _A_in["dft_seq_re"],
        "A_dft_seq_im": _A_in["dft_seq_im"],
        "A_dft_hid_re": _A_in["dft_hid_re"],
        "A_dft_hid_im": _A_in["dft_hid_im"],
        "B_x": _B_in["x"],
        "B_wqkv": _B_in["wqkv"],
        "B_w_phi": _B_in["w_phi"],
        "B_wo": _B_in["wo"],
    }

def reference(A_x, A_dft_seq_re, A_dft_seq_im, A_dft_hid_re, A_dft_hid_im, B_x, B_wqkv, B_w_phi, B_wo):
    def _A_ref(x, dft_seq_re, dft_seq_im, dft_hid_re, dft_hid_im):
        a = torch.einsum("bsd,ed->bse", x, dft_hid_re)
        b = torch.einsum("bsd,ed->bse", x, dft_hid_im)
        y = torch.einsum("ts,bse->bte", dft_seq_re, a) - torch.einsum("ts,bse->bte", dft_seq_im, b)
        return y

    def _B_ref(x, wqkv, w_phi, wo):
        B, S, D = x.shape
        H = 16; Dh = D // H
        qkv = (lambda x, *d: x.permute(*d))((x @ wqkv).reshape(B, S, 3, H, Dh), 2, 0, 3, 1, 4)
        q, k, v = qkv[0], qkv[1], qkv[2]
        pq = torch.einsum("bhsd,hdf->bhsf", q, w_phi)
        pk = torch.einsum("bhsd,hdf->bhsf", k, w_phi)
        phi_q = torch.concatenate([_softmax(pq, axis=-1), _softmax(-pq, axis=-1)], axis=-1)
        phi_k = torch.concatenate([_softmax(pk, axis=-1), _softmax(-pk, axis=-1)], axis=-1)
        kv = torch.einsum("bhsf,bhsd->bhfd", phi_k, v)
        z  = torch.einsum("bhsf->bhf", phi_k)
        num = torch.einsum("bhqf,bhfd->bhqd", phi_q, kv)
        den = torch.einsum("bhqf,bhf->bhq", phi_q, z)[..., None] + 1e-6
        o = num / den
        return (lambda x, *d: x.permute(*d))(o, 0, 2, 1, 3).reshape(B, S, D) @ wo

    a = _A_ref(A_x, A_dft_seq_re, A_dft_seq_im, A_dft_hid_re, A_dft_hid_im)
    b = _B_ref(B_x, B_wqkv, B_w_phi, B_wo)
    return torch.concatenate([a, b], axis=-1)
```

```asm
; @launch grid=(256,1,1) block=(512,1,1) lds=163840
.amdgcn_target "amdgcn-amd-amdhsa--gfx950"
.text
.globl concat_heads__spectral_fnet__linear_kernel_hedgehog__prompt_kernel
.p2align 8
.type concat_heads__spectral_fnet__linear_kernel_hedgehog__prompt_kernel,@function
concat_heads__spectral_fnet__linear_kernel_hedgehog__prompt_kernel:
s_load_dwordx16 s[8:23], s[0:1], 0
s_load_dwordx8 s[24:31], s[0:1], 64
s_cmp_ge_u32 s2, 256
s_cbranch_scc1 LEND
s_memrealtime s[90:91]
v_lshrrev_b32 v1, 6, v0
v_and_b32 v0, 63, v0
v_mov_b32 v10, 155648
v_mov_b32 v11, 0
v_lshl_add_u32 v2, v0, 2, v10
ds_write_b32 v2, v11
v_mov_b32 v11, 1
s_and_b32 s72, s2, 7
s_lshr_b32 s73, s2, 3
v_readfirstlane_b32 s76, v1
s_and_b32 s74, s72, 3
s_lshl_b32 s74, s74, 2
s_lshr_b32 s80, s73, 3
s_add_u32 s74, s74, s80
s_lshr_b32 s75, s72, 2
s_lshl_b32 s75, s75, 3
s_and_b32 s80, s73, 7
s_add_u32 s75, s75, s80
s_lshl_b32 s77, s74, 1
s_add_u32 s77, s77, s75
s_mul_i32 s80, s77, 37
s_lshr_b32 s80, s80, 8
s_mul_i32 s80, s80, 7
s_sub_u32 s77, s77, s80
s_mov_b32 s78, 0x200000
s_cmp_lt_u32 s76, 4
s_cbranch_scc1 LB
s_sub_u32 s76, s76, 4
s_setprio 1
v_lshrrev_b32 v12, 3, v0
v_mul_u32_u24 v4, 896, v12
v_and_b32 v14, 7, v0
v_lshrrev_b32 v1, 4, v0
v_xor_b32 v14, v14, v1
v_lshlrev_b32 v14, 4, v14
v_lshl_add_u32 v8, v4, 6, v14
v_add_u32 v4, v4, v14
v_xor_b32 v5, 64, v4
v_add_u32 v6, 12288, v4
v_add_u32 v7, 18432, v5
v_add_u32 v5, 6144, v5
s_lshl_b32 s63, s75, 2
s_add_u32 s63, s63, s76
s_mul_i32 s63, s63, 28672
s_mov_b32 s62, s77
s_lshl_b32 s87, s76, 12
s_add_u32 s87, s87, 57344
v_lshrrev_b32 v12, 2, v0
v_mul_u32_u24 v2, 2688, v12
v_and_b32 v12, 3, v0
v_lshl_add_u32 v2, v12, 4, v2
v_add_u32 v3, 41984, v2
s_and_b32 s80, s76, 1
s_mul_i32 s86, s80, 86016
s_lshr_b32 s80, s76, 1
s_add_u32 s80, s80, 1
s_mul_i32 s80, s80, 896
s_add_u32 s86, s86, s80
s_mul_i32 s80, s74, 56
s_add_u32 s86, s86, s80
s_lshl_b32 s88, s76, 11
s_mov_b32 s89, s77
s_waitcnt lgkmcnt(0)
s_mov_b32 s32, s18
s_mov_b32 s33, s19
s_mov_b32 s34, 1835008
s_mov_b32 s35, 0x20000
s_mov_b32 s36, s20
s_mov_b32 s37, s21
s_mov_b32 s38, 1204224
s_mov_b32 s39, 0x20000
s_lshl_b32 s81, s62, 7
s_add_u32 s81, s81, s63
s_add_u32 m0, s87, 0
s_add_u32 s62, s62, 1
buffer_load_dwordx4 v4, s[32:35], s81 offen offset:0 lds
buffer_load_dwordx4 v5, s[32:35], s81 offen offset:1024 lds
buffer_load_dwordx4 v6, s[32:35], s81 offen offset:2048 lds
buffer_load_dwordx4 v7, s[32:35], s81 offen offset:3072 lds
s_cmp_eq_u32 s62, 7
s_cselect_b32 s62, 0, s62
s_mul_i32 s82, s89, 172032
s_add_u32 m0, s88, 0
s_add_u32 s82, s82, s86
s_add_u32 s89, s89, 1
buffer_load_dwordx4 v2, s[36:39], s82 offen offset:0 lds
buffer_load_dwordx4 v3, s[36:39], s82 offen offset:1024 lds
s_cmp_eq_u32 s89, 7
s_cselect_b32 s89, 0, s89
s_lshr_b32 s80, s73, 2
s_lshl_b32 s5, s72, 3
s_add_u32 s5, s5, s80
s_and_b32 s3, s73, 3
s_mov_b32 s40, s8
s_mov_b32 s41, s9
s_mov_b32 s42, 1835008
s_mov_b32 s43, 0x20000
v_lshlrev_b32 v9, 4, v0
s_getpc_b64 s[6:7]
Lpc_1:
s_add_u32 s6, s6, LTAB-Lpc_1
s_addc_u32 s7, s7, 0
v_mov_b32 v29, 0
s_or_b32 s80, s2, s76
s_cmp_lg_u32 s80, 0
s_cbranch_scc1 Lnon_2
s_or_b32 s80, s90, 1
v_mov_b32 v12, s80
s_mov_b64 exec, 1
global_store_dword v29, v12, s[28:29] sc1
s_mov_b64 exec, -1
Lnon_2:
s_lshl_b32 s80, s3, 6
s_and_b32 s84, s76, 1
s_lshl_b32 s84, s84, 5
s_add_u32 s80, s80, s84
v_and_b32 v98, 31, v0
v_add_u32 v98, s80, v98
s_cmp_lt_u32 s76, 2
s_cselect_b32 s84, 0, 0x3e800000
s_mov_b32 s85, 0x3b124925
v_cvt_f32_u32 v1, v98
v_mul_f32 v1, s85, v1
v_sin_f32 v12, v1
v_cos_f32 v14, v1
v_lshrrev_b32 v99, 5, v0
v_mul_u32_u24 v99, 224, v99
v_add_u32 v99, 444, v99
v_mul_u32_u24 v99, v99, v98
v_mul_f32 v12, v12, v12
v_mul_f32 v14, v14, v14
v_cmp_lt_f32 vcc, v12, v14
v_fma_f32 v12, v12, -4.0, 2.0
v_fma_f32 v14, v14, 4.0, -2.0
v_cndmask_b32 v96, v14, v12, vcc
v_mov_b32 v100, s84
v_lshrrev_b32 v1, 6, v99
v_mul_u32_u24 v1, 9363, v1
v_lshrrev_b32 v1, 16, v1
v_mul_u32_u24 v1, 448, v1
v_sub_u32 v1, v99, v1
v_cvt_f32_u32 v1, v1
v_fma_f32 v1, v1, s85, v100
v_cos_f32 v92, v1
v_add_u32 v99, v99, v98
v_lshrrev_b32 v1, 6, v99
v_mul_u32_u24 v1, 9363, v1
v_lshrrev_b32 v1, 16, v1
v_mul_u32_u24 v1, 448, v1
v_sub_u32 v1, v99, v1
v_cvt_f32_u32 v1, v1
v_fma_f32 v1, v1, s85, v100
v_cos_f32 v93, v1
v_add_u32 v99, v99, v98
v_lshrrev_b32 v1, 6, v99
v_mul_u32_u24 v1, 9363, v1
v_lshrrev_b32 v1, 16, v1
v_mul_u32_u24 v1, 448, v1
v_sub_u32 v1, v99, v1
v_cvt_f32_u32 v1, v1
v_fma_f32 v1, v1, s85, v100
v_cos_f32 v94, v1
v_add_u32 v99, v99, v98
v_lshrrev_b32 v1, 6, v99
v_mul_u32_u24 v1, 9363, v1
v_lshrrev_b32 v1, 16, v1
v_mul_u32_u24 v1, 448, v1
v_sub_u32 v1, v99, v1
v_cvt_f32_u32 v1, v1
v_fma_f32 v1, v1, s85, v100
v_cos_f32 v95, v1
s_mov_b32 s80, 0
Lgen_3:
v_pk_fma_f32 v[80:81], v[96:97], v[94:95], v[92:93] op_sel_hi:[0,1,1] neg_lo:[0,0,1] neg_hi:[0,0,1]
s_nop 0
v_pk_fma_f32 v[82:83], v[96:97], v[80:81], v[94:95] op_sel_hi:[0,1,1] neg_lo:[0,0,1] neg_hi:[0,0,1]
s_nop 0
v_pk_fma_f32 v[84:85], v[96:97], v[82:83], v[80:81] op_sel_hi:[0,1,1] neg_lo:[0,0,1] neg_hi:[0,0,1]
s_nop 0
v_pk_fma_f32 v[86:87], v[96:97], v[84:85], v[82:83] op_sel_hi:[0,1,1] neg_lo:[0,0,1] neg_hi:[0,0,1]
s_nop 0
v_pk_fma_f32 v[88:89], v[96:97], v[86:87], v[84:85] op_sel_hi:[0,1,1] neg_lo:[0,0,1] neg_hi:[0,0,1]
s_nop 0
v_pk_fma_f32 v[90:91], v[96:97], v[88:89], v[86:87] op_sel_hi:[0,1,1] neg_lo:[0,0,1] neg_hi:[0,0,1]
s_nop 0
v_pk_fma_f32 v[92:93], v[96:97], v[90:91], v[88:89] op_sel_hi:[0,1,1] neg_lo:[0,0,1] neg_hi:[0,0,1]
s_nop 0
v_pk_fma_f32 v[94:95], v[96:97], v[92:93], v[90:91] op_sel_hi:[0,1,1] neg_lo:[0,0,1] neg_hi:[0,0,1]
s_set_gpr_idx_on s80, gpr_idx(DST)
v_cvt_pk_bf16_f32 v128, v80, v81
v_cvt_pk_bf16_f32 v129, v82, v83
v_cvt_pk_bf16_f32 v130, v84, v85
v_cvt_pk_bf16_f32 v131, v86, v87
v_cvt_pk_bf16_f32 v132, v88, v89
v_cvt_pk_bf16_f32 v133, v90, v91
v_cvt_pk_bf16_f32 v134, v92, v93
v_cvt_pk_bf16_f32 v135, v94, v95
s_set_gpr_idx_off
s_add_u32 s80, s80, 8
s_cmp_lt_u32 s80, 112
s_cbranch_scc1 Lgen_3
s_mov_b32 s44, s24
s_mov_b32 s45, s25
s_mov_b32 s46, 401408
s_mov_b32 s47, 0x20000
s_mov_b32 s48, s30
s_mov_b32 s49, s31
s_mov_b32 s50, 268435456
s_mov_b32 s51, 0x20000
s_mov_b32 s52, s26
s_mov_b32 s53, s27
s_mov_b32 s54, 3670016
s_mov_b32 s55, 0x20000
v_and_b32 v1, 31, v0
v_lshrrev_b32 v14, 5, v0
v_bfe_u32 v12, v0, 1, 3
v_lshlrev_b32 v14, 2, v14
v_xor_b32 v12, v12, v14
v_lshlrev_b32 v1, 7, v1
v_lshl_add_u32 v1, v12, 4, v1
v_add_u32 v1, 122880, v1
v_mul_u32_u24 v14, 3072, v14
v_add_u32 v1, v1, v14
v_lshrrev_b32 v14, 5, v0
v_lshlrev_b32 v14, 12, v14
v_xor_b32 v48, 0, v1
v_xor_b32 v49, 16, v1
v_xor_b32 v50, 32, v1
v_xor_b32 v51, 48, v1
v_xor_b32 v52, 64, v1
v_add_u32 v52, v52, v14
v_xor_b32 v53, 80, v1
v_add_u32 v53, v53, v14
v_xor_b32 v54, 96, v1
v_add_u32 v54, v54, v14
v_xor_b32 v55, 112, v1
v_add_u32 v55, v55, v14
s_lshl_b32 s80, s76, 11
s_add_u32 s80, s80, 122880
v_and_b32 v1, 31, v0
v_lshlrev_b32 v1, 6, v1
v_bfe_u32 v12, v0, 1, 2
v_lshl_add_u32 v1, v12, 4, v1
v_lshrrev_b32 v12, 5, v0
v_lshl_add_u32 v1, v12, 3, v1
v_add_u32 v1, s80, v1
v_xor_b32 v56, 0, v1
v_xor_b32 v57, 16, v1
v_xor_b32 v58, 32, v1
v_xor_b32 v59, 48, v1
v_bfe_u32 v12, v0, 3, 2
v_and_b32 v1, 3, v0
v_xor_b32 v12, v12, v1
v_lshrrev_b32 v60, 2, v0
v_lshlrev_b32 v60, 6, v60
v_lshl_add_u32 v60, v12, 4, v60
v_add_u32 v60, s80, v60
s_bfe_u32 s80, s5, 0x10001
s_bfe_u32 s84, s5, 0x10003
s_lshl_b32 s84, s84, 1
s_or_b32 s80, s80, s84
s_lshl_b32 s80, s80, 5
s_and_b32 s84, s76, 1
s_lshl_b32 s84, s84, 6
s_xor_b32 s80, s80, s84
v_lshlrev_b32 v1, 4, v1
v_xor_b32 v1, s80, v1
v_lshrrev_b32 v12, 3, v0
v_lshl_add_u32 v1, v12, 17, v1
v_bfe_u32 v12, v0, 2, 1
v_lshl_add_u32 v61, v12, 13, v1
s_lshl_b32 s80, s3, 1
s_lshr_b32 s84, s76, 1
s_add_u32 s80, s80, s84
s_lshl_b32 s66, s80, 14
s_lshl_b32 s84, s5, 7
s_add_u32 s66, s66, s84
s_add_u32 s66, s66, 4202496
s_add_u32 s67, s66, 0x100000
v_lshrrev_b32 v1, 3, v0
v_bfe_u32 v12, v0, 4, 1
v_lshlrev_b32 v12, 2, v12
v_and_b32 v14, 7, v0
v_xor_b32 v12, v12, v14
v_mul_u32_u24 v1, 896, v1
v_lshl_add_u32 v16, v12, 4, v1
s_lshr_b32 s80, 0xaa54, s74
s_bitcmp1_b32 s80, 0
s_cbranch_scc1 Lcl_4
s_lshl_b32 s81, s62, 7
s_add_u32 s81, s81, s63
s_add_u32 m0, s87, 16384
s_nop 0
buffer_load_dwordx4 v4, s[32:35], s81 offen offset:0 lds
buffer_load_dwordx4 v5, s[32:35], s81 offen offset:1024 lds
s_waitcnt vmcnt(2)
s_barrier
s_lshl_b32 s81, s62, 7
s_add_u32 s81, s81, s63
s_add_u32 m0, s87, 16384
s_add_u32 s62, s62, 1
buffer_load_dwordx4 v6, s[32:35], s81 offen offset:2048 lds
buffer_load_dwordx4 v7, s[32:35], s81 offen offset:3072 lds
s_cmp_eq_u32 s62, 7
s_cselect_b32 s62, 0, s62
s_mul_i32 s82, s89, 172032
s_add_u32 m0, s88, 8192
s_add_u32 s82, s82, s86
s_add_u32 s89, s89, 1
buffer_load_dwordx4 v2, s[36:39], s82 offen offset:0 lds
buffer_load_dwordx4 v3, s[36:39], s82 offen offset:1024 lds
s_cmp_eq_u32 s89, 7
s_cselect_b32 s89, 0, s89
s_lshl_b32 s81, s62, 7
s_add_u32 s81, s81, s63
s_add_u32 m0, s87, 32768
s_nop 0
buffer_load_dwordx4 v4, s[32:35], s81 offen offset:0 lds
buffer_load_dwordx4 v5, s[32:35], s81 offen offset:1024 lds
s_waitcnt vmcnt(2)
s_barrier
s_lshl_b32 s81, s62, 7
s_add_u32 s81, s81, s63
s_add_u32 m0, s87, 32768
s_add_u32 s62, s62, 1
buffer_load_dwordx4 v6, s[32:35], s81 offen offset:2048 lds
buffer_load_dwordx4 v7, s[32:35], s81 offen offset:3072 lds
s_cmp_eq_u32 s62, 7
s_cselect_b32 s62, 0, s62
s_mul_i32 s82, s89, 172032
s_add_u32 m0, s88, 16384
s_add_u32 s82, s82, s86
s_add_u32 s89, s89, 1
buffer_load_dwordx4 v2, s[36:39], s82 offen offset:0 lds
buffer_load_dwordx4 v3, s[36:39], s82 offen offset:1024 lds
s_cmp_eq_u32 s89, 7
s_cselect_b32 s89, 0, s89
s_lshl_b32 s81, s62, 7
s_add_u32 s81, s81, s63
s_add_u32 m0, s87, 49152
s_nop 0
buffer_load_dwordx4 v4, s[32:35], s81 offen offset:0 lds
buffer_load_dwordx4 v5, s[32:35], s81 offen offset:1024 lds
global_load_dword v13, v29, s[28:29] sc1
s_waitcnt vmcnt(3)
s_barrier
s_lshl_b32 s81, s62, 7
s_add_u32 s81, s81, s63
s_add_u32 m0, s87, 49152
s_add_u32 s62, s62, 1
buffer_load_dwordx4 v6, s[32:35], s81 offen offset:2048 lds
buffer_load_dwordx4 v7, s[32:35], s81 offen offset:3072 lds
s_cmp_eq_u32 s62, 7
s_cselect_b32 s62, 0, s62
s_mul_i32 s82, s89, 172032
s_add_u32 m0, s88, 24576
s_add_u32 s82, s82, s86
s_add_u32 s89, s89, 1
buffer_load_dwordx4 v2, s[36:39], s82 offen offset:0 lds
buffer_load_dwordx4 v3, s[36:39], s82 offen offset:1024 lds
s_cmp_eq_u32 s89, 7
s_cselect_b32 s89, 0, s89
s_lshl_b32 s81, s62, 7
s_add_u32 s81, s81, s63
s_add_u32 m0, s87, 0
s_nop 0
buffer_load_dwordx4 v4, s[32:35], s81 offen offset:0 lds
buffer_load_dwordx4 v5, s[32:35], s81 offen offset:1024 lds
s_waitcnt vmcnt(2)
s_barrier
s_lshl_b32 s81, s62, 7
s_add_u32 s81, s81, s63
s_add_u32 m0, s87, 0
s_add_u32 s62, s62, 1
buffer_load_dwordx4 v6, s[32:35], s81 offen offset:2048 lds
buffer_load_dwordx4 v7, s[32:35], s81 offen offset:3072 lds
s_cmp_eq_u32 s62, 7
s_cselect_b32 s62, 0, s62
s_mul_i32 s82, s89, 172032
s_add_u32 m0, s88, 32768
s_add_u32 s82, s82, s86
s_add_u32 s89, s89, 1
buffer_load_dwordx4 v2, s[36:39], s82 offen offset:0 lds
buffer_load_dwordx4 v3, s[36:39], s82 offen offset:1024 lds
s_cmp_eq_u32 s89, 7
s_cselect_b32 s89, 0, s89
s_lshl_b32 s81, s62, 7
s_add_u32 s81, s81, s63
s_add_u32 m0, s87, 16384
s_nop 0
buffer_load_dwordx4 v4, s[32:35], s81 offen offset:0 lds
buffer_load_dwordx4 v5, s[32:35], s81 offen offset:1024 lds
s_waitcnt vmcnt(2)
s_barrier
s_lshl_b32 s81, s62, 7
s_add_u32 s81, s81, s63
s_add_u32 m0, s87, 16384
s_add_u32 s62, s62, 1
buffer_load_dwordx4 v6, s[32:35], s81 offen offset:2048 lds
buffer_load_dwordx4 v7, s[32:35], s81 offen offset:3072 lds
s_cmp_eq_u32 s62, 7
s_cselect_b32 s62, 0, s62
s_mul_i32 s82, s89, 172032
s_add_u32 m0, s88, 40960
s_add_u32 s82, s82, s86
s_add_u32 s89, s89, 1
buffer_load_dwordx4 v2, s[36:39], s82 offen offset:0 lds
buffer_load_dwordx4 v3, s[36:39], s82 offen offset:1024 lds
s_cmp_eq_u32 s89, 7
s_cselect_b32 s89, 0, s89
s_lshl_b32 s81, s62, 7
s_add_u32 s81, s81, s63
s_add_u32 m0, s87, 32768
s_nop 0
buffer_load_dwordx4 v4, s[32:35], s81 offen offset:0 lds
buffer_load_dwordx4 v5, s[32:35], s81 offen offset:1024 lds
s_waitcnt vmcnt(2)
s_barrier
s_lshl_b32 s81, s62, 7
s_add_u32 s81, s81, s63
s_add_u32 m0, s87, 32768
s_add_u32 s62, s62, 1
buffer_load_dwordx4 v6, s[32:35], s81 offen offset:2048 lds
buffer_load_dwordx4 v7, s[32:35], s81 offen offset:3072 lds
s_cmp_eq_u32 s62, 7
s_cselect_b32 s62, 0, s62
s_mul_i32 s82, s89, 172032
s_add_u32 m0, s88, 49152
s_add_u32 s82, s82, s86
s_add_u32 s89, s89, 1
buffer_load_dwordx4 v2, s[36:39], s82 offen offset:0 lds
buffer_load_dwordx4 v3, s[36:39], s82 offen offset:1024 lds
s_cmp_eq_u32 s89, 7
s_cselect_b32 s89, 0, s89
Lnr_5:
v_readfirstlane_b32 s79, v13
s_nop 0
s_cmp_lg_u32 s79, 0
s_cbranch_scc1 Lnr_5x
s_sub_u32 s78, s78, 64
s_cbranch_scc1 Lnr_5x
global_load_dword v13, v29, s[28:29] sc1
s_waitcnt vmcnt(0)
s_branch Lnr_5
Lnr_5x:
ds_write_b32 v10, v13 offset:44
s_waitcnt vmcnt(0)
s_waitcnt lgkmcnt(0)
s_barrier
s_branch Lcl_4x
Lcl_4:
s_lshl_b32 s81, s62, 7
s_add_u32 s81, s81, s63
s_add_u32 m0, s87, 16384
s_nop 0
buffer_load_dwordx4 v4, s[32:35], s81 offen offset:0 lds
buffer_load_dwordx4 v5, s[32:35], s81 offen offset:1024 lds
s_lshl_b32 s81, s62, 7
s_add_u32 s81, s81, s63
s_add_u32 m0, s87, 16384
s_add_u32 s62, s62, 1
buffer_load_dwordx4 v6, s[32:35], s81 offen offset:2048 lds
buffer_load_dwordx4 v7, s[32:35], s81 offen offset:3072 lds
s_cmp_eq_u32 s62, 7
s_cselect_b32 s62, 0, s62
s_mul_i32 s82, s89, 172032
s_add_u32 m0, s88, 8192
s_add_u32 s82, s82, s86
s_add_u32 s89, s89, 1
buffer_load_dwordx4 v2, s[36:39], s82 offen offset:0 lds
buffer_load_dwordx4 v3, s[36:39], s82 offen offset:1024 lds
s_cmp_eq_u32 s89, 7
s_cselect_b32 s89, 0, s89
s_waitcnt vmcnt(6)
s_barrier
s_lshl_b32 s81, s62, 7
s_add_u32 s81, s81, s63
s_add_u32 m0, s87, 32768
s_nop 0
buffer_load_dwordx4 v4, s[32:35], s81 offen offset:0 lds
buffer_load_dwordx4 v5, s[32:35], s81 offen offset:1024 lds
s_lshl_b32 s81, s62, 7
s_add_u32 s81, s81, s63
s_add_u32 m0, s87, 32768
s_add_u32 s62, s62, 1
buffer_load_dwordx4 v6, s[32:35], s81 offen offset:2048 lds
buffer_load_dwordx4 v7, s[32:35], s81 offen offset:3072 lds
s_cmp_eq_u32 s62, 7
s_cselect_b32 s62, 0, s62
s_mul_i32 s82, s89, 172032
s_add_u32 m0, s88, 16384
s_add_u32 s82, s82, s86
s_add_u32 s89, s89, 1
buffer_load_dwordx4 v2, s[36:39], s82 offen offset:0 lds
buffer_load_dwordx4 v3, s[36:39], s82 offen offset:1024 lds
s_cmp_eq_u32 s89, 7
s_cselect_b32 s89, 0, s89
s_waitcnt vmcnt(6)
s_barrier
s_lshl_b32 s81, s62, 7
s_add_u32 s81, s81, s63
s_add_u32 m0, s87, 49152
s_nop 0
buffer_load_dwordx4 v4, s[32:35], s81 offen offset:0 lds
buffer_load_dwordx4 v5, s[32:35], s81 offen offset:1024 lds
s_lshl_b32 s81, s62, 7
s_add_u32 s81, s81, s63
s_add_u32 m0, s87, 49152
s_add_u32 s62, s62, 1
buffer_load_dwordx4 v6, s[32:35], s81 offen offset:2048 lds
buffer_load_dwordx4 v7, s[32:35], s81 offen offset:3072 lds
s_cmp_eq_u32 s62, 7
s_cselect_b32 s62, 0, s62
s_mul_i32 s82, s89, 172032
s_add_u32 m0, s88, 24576
s_add_u32 s82, s82, s86
s_add_u32 s89, s89, 1
buffer_load_dwordx4 v2, s[36:39], s82 offen offset:0 lds
buffer_load_dwordx4 v3, s[36:39], s82 offen offset:1024 lds
s_cmp_eq_u32 s89, 7
s_cselect_b32 s89, 0, s89
global_load_dword v13, v29, s[28:29] sc1
s_waitcnt vmcnt(7)
s_barrier
s_lshl_b32 s81, s62, 7
s_add_u32 s81, s81, s63
s_add_u32 m0, s87, 0
s_nop 0
buffer_load_dwordx4 v4, s[32:35], s81 offen offset:0 lds
buffer_load_dwordx4 v5, s[32:35], s81 offen offset:1024 lds
s_lshl_b32 s81, s62, 7
s_add_u32 s81, s81, s63
s_add_u32 m0, s87, 0
s_add_u32 s62, s62, 1
buffer_load_dwordx4 v6, s[32:35], s81 offen offset:2048 lds
buffer_load_dwordx4 v7, s[32:35], s81 offen offset:3072 lds
s_cmp_eq_u32 s62, 7
s_cselect_b32 s62, 0, s62
s_mul_i32 s82, s89, 172032
s_add_u32 m0, s88, 32768
s_add_u32 s82, s82, s86
s_add_u32 s89, s89, 1
buffer_load_dwordx4 v2, s[36:39], s82 offen offset:0 lds
buffer_load_dwordx4 v3, s[36:39], s82 offen offset:1024 lds
s_cmp_eq_u32 s89, 7
s_cselect_b32 s89, 0, s89
s_waitcnt vmcnt(7)
s_barrier
s_lshl_b32 s81, s62, 7
s_add_u32 s81, s81, s63
s_add_u32 m0, s87, 16384
s_nop 0
buffer_load_dwordx4 v4, s[32:35], s81 offen offset:0 lds
buffer_load_dwordx4 v5, s[32:35], s81 offen offset:1024 lds
s_lshl_b32 s81, s62, 7
s_add_u32 s81, s81, s63
s_add_u32 m0, s87, 16384
s_add_u32 s62, s62, 1
buffer_load_dwordx4 v6, s[32:35], s81 offen offset:2048 lds
buffer_load_dwordx4 v7, s[32:35], s81 offen offset:3072 lds
s_cmp_eq_u32 s62, 7
s_cselect_b32 s62, 0, s62
s_mul_i32 s82, s89, 172032
s_add_u32 m0, s88, 40960
s_add_u32 s82, s82, s86
s_add_u32 s89, s89, 1
buffer_load_dwordx4 v2, s[36:39], s82 offen offset:0 lds
buffer_load_dwordx4 v3, s[36:39], s82 offen offset:1024 lds
s_cmp_eq_u32 s89, 7
s_cselect_b32 s89, 0, s89
s_waitcnt vmcnt(6)
s_barrier
s_lshl_b32 s81, s62, 7
s_add_u32 s81, s81, s63
s_add_u32 m0, s87, 32768
s_nop 0
buffer_load_dwordx4 v4, s[32:35], s81 offen offset:0 lds
buffer_load_dwordx4 v5, s[32:35], s81 offen offset:1024 lds
s_lshl_b32 s81, s62, 7
s_add_u32 s81, s81, s63
s_add_u32 m0, s87, 32768
s_add_u32 s62, s62, 1
buffer_load_dwordx4 v6, s[32:35], s81 offen offset:2048 lds
buffer_load_dwordx4 v7, s[32:35], s81 offen offset:3072 lds
s_cmp_eq_u32 s62, 7
s_cselect_b32 s62, 0, s62
s_mul_i32 s82, s89, 172032
s_add_u32 m0, s88, 49152
s_add_u32 s82, s82, s86
s_add_u32 s89, s89, 1
buffer_load_dwordx4 v2, s[36:39], s82 offen offset:0 lds
buffer_load_dwordx4 v3, s[36:39], s82 offen offset:1024 lds
s_cmp_eq_u32 s89, 7
s_cselect_b32 s89, 0, s89
s_waitcnt vmcnt(6)
s_barrier
Lnr_6:
v_readfirstlane_b32 s79, v13
s_nop 0
s_cmp_lg_u32 s79, 0
s_cbranch_scc1 Lnr_6x
s_sub_u32 s78, s78, 64
s_cbranch_scc1 Lnr_6x
global_load_dword v13, v29, s[28:29] sc1
s_waitcnt vmcnt(0)
s_branch Lnr_6
Lnr_6x:
ds_write_b32 v10, v13 offset:44
s_waitcnt vmcnt(0)
s_waitcnt lgkmcnt(0)
s_barrier
Lcl_4x:
s_mul_i32 s85, s76, 43008
s_mul_i32 s80, s74, 56
s_add_u32 s85, s85, s80
s_lshl_b32 s80, s76, 10
s_add_u32 m0, s80, 0
s_mov_b32 s84, s77
s_mul_i32 s82, s84, 172032
s_add_u32 s82, s82, s85
buffer_load_dwordx4 v2, s[36:39], s82 offen lds
s_add_u32 m0, m0, 4096
s_add_u32 s84, s84, 1
s_cmp_eq_u32 s84, 7
s_cselect_b32 s84, 0, s84
s_mul_i32 s82, s84, 172032
s_add_u32 s82, s82, s85
buffer_load_dwordx4 v2, s[36:39], s82 offen lds
s_add_u32 m0, m0, 4096
s_add_u32 s84, s84, 1
s_cmp_eq_u32 s84, 7
s_cselect_b32 s84, 0, s84
s_mul_i32 s82, s84, 172032
s_add_u32 s82, s82, s85
buffer_load_dwordx4 v2, s[36:39], s82 offen lds
s_add_u32 m0, m0, 4096
s_add_u32 s84, s84, 1
s_cmp_eq_u32 s84, 7
s_cselect_b32 s84, 0, s84
s_mul_i32 s82, s84, 172032
s_add_u32 s82, s82, s85
buffer_load_dwordx4 v2, s[36:39], s82 offen lds
s_add_u32 m0, m0, 4096
s_add_u32 s84, s84, 1
s_cmp_eq_u32 s84, 7
s_cselect_b32 s84, 0, s84
s_mul_i32 s82, s84, 172032
s_add_u32 s82, s82, s85
buffer_load_dwordx4 v2, s[36:39], s82 offen lds
s_add_u32 m0, m0, 4096
s_add_u32 s84, s84, 1
s_cmp_eq_u32 s84, 7
s_cselect_b32 s84, 0, s84
s_mul_i32 s82, s84, 172032
s_add_u32 s82, s82, s85
buffer_load_dwordx4 v2, s[36:39], s82 offen lds
s_add_u32 m0, m0, 4096
s_add_u32 s84, s84, 1
s_cmp_eq_u32 s84, 7
s_cselect_b32 s84, 0, s84
s_mul_i32 s82, s84, 172032
s_add_u32 s82, s82, s85
buffer_load_dwordx4 v2, s[36:39], s82 offen lds
s_setprio 0
s_and_b32 s80, s73, 7
s_cmp_eq_u32 s80, 7
s_cselect_b32 s46, 0, s46
s_and_b32 s80, s76, 1
s_lshl_b32 s80, s80, 6
v_xor_b32 v8, s80, v8
s_lshl_b32 s70, s76, 9
s_add_u32 s70, s70, s5
s_mul_i32 s70, s70, 896
s_lshl_b32 s69, s3, 1
s_and_b32 s69, s69, 7
s_lshl_b32 s80, s69, 2
s_add_u32 s80, s80, s76
s_lshl_b32 s80, s80, 10
s_add_u32 m0, s80, 122880
s_lshl_b32 s81, s69, 7
s_add_u32 s81, s81, s70
buffer_load_dwordx4 v8, s[40:43], s81 offen lds
s_add_u32 s69, s69, 1
s_cmp_eq_u32 s69, 7
s_cselect_b32 s69, 0, s69
s_lshl_b32 s80, s69, 2
s_add_u32 s80, s80, s76
s_lshl_b32 s80, s80, 10
s_add_u32 m0, s80, 122880
s_lshl_b32 s81, s69, 7
s_add_u32 s81, s81, s70
buffer_load_dwordx4 v8, s[40:43], s81 offen lds
s_mul_i32 s80, s79, 0x9e3779b1
v_and_b32 v1, 3, v0
v_cmp_lt_u32 vcc, 1, v1
v_mov_b32 v12, s80
v_and_b32 v14, 1, v0
v_cndmask_b32 v12, v13, v12, vcc
v_lshlrev_b32 v14, 4, v14
v_xor_b32 v14, 16, v14
v_lshlrev_b32 v12, v14, v12
v_and_b32 v4, 0xbfff0000, v12
s_mov_b32 s86, 0xffff
v_and_b32 v12, 15, v0
v_bfe_u32 v14, v0, 4, 1
v_lshlrev_b32 v1, 4, v12
v_lshl_add_u32 v1, v14, 9, v1
v_lshrrev_b32 v7, 5, v0
v_lshl_add_u32 v5, v7, 12, v1
v_lshl_add_u32 v6, v7, 3, v1
s_lshl_b32 s80, s76, 10
s_add_u32 s84, s80, 159744
v_add_u32 v6, s84, v6
s_lshl_b32 s87, s74, 16
s_add_u32 s87, s87, s80
s_add_u32 s87, s87, 4096
v_lshlrev_b32 v14, 2, v14
v_sub_u32 v12, v12, v14
v_bfe_u32 v14, v12, 1, 1
v_bfe_u32 v1, v12, 3, 1
v_lshl_or_b32 v14, v1, 1, v14
v_and_or_b32 v14, v12, 4, v14
v_and_b32 v12, 1, v12
v_lshlrev_b32 v12, 4, v12
v_mov_b32 v1, 0x3f80
v_lshlrev_b32 v12, v12, v1
v_cmp_eq_u32 vcc, 0, v14
s_nop 1
v_cndmask_b32 v124, 0, v12, vcc
v_cmp_eq_u32 vcc, 1, v14
s_nop 1
v_cndmask_b32 v125, 0, v12, vcc
v_cmp_eq_u32 vcc, 2, v14
s_nop 1
v_cndmask_b32 v126, 0, v12, vcc
v_cmp_eq_u32 vcc, 3, v14
s_nop 1
v_cndmask_b32 v127, 0, v12, vcc
v_mov_b32 v120, 0
v_mov_b32 v121, 0
v_mov_b32 v122, 0
v_mov_b32 v123, 0
v_mov_b32 v108, 0
v_mov_b32 v109, 0
v_mov_b32 v110, 0
v_mov_b32 v111, 0
Lw_7:
ds_read_b32 v12, v10 offset:32
s_sub_u32 s78, s78, 1
s_cbranch_scc1 LEND
s_waitcnt lgkmcnt(0)
v_readfirstlane_b32 s80, v12
s_nop 0
s_cmp_ge_u32 s80, 4
s_cbranch_scc0 Lw_7
s_mul_i32 s60, s76, 7168
s_add_u32 s61, s60, 28672
s_mul_i32 s60, s60, 7
s_and_b32 s80, s73, 7
s_lshl_b32 s80, s80, 7
s_add_u32 s60, s60, s80
s_lshr_b32 s71, s73, 3
s_mul_i32 s71, s71, 7
s_lshr_b32 s71, s71, 1
s_cmp_ge_u32 s71, 7
s_cselect_b32 s80, 21, 0
s_cselect_b32 s84, 54272, 0
s_add_u32 s80, s80, s71
s_mul_i32 s80, s80, 7168
s_add_u32 s80, s80, s60
s_add_u32 s84, s84, s61
s_lshl_b32 s85, s71, 10
s_add_u32 m0, s84, s85
s_nop 0
buffer_load_dwordx4 v16, s[44:47], s80 offen lds
s_add_u32 s71, s71, 1
s_cmp_eq_u32 s71, 14
s_cselect_b32 s71, 0, s71
s_cmp_ge_u32 s71, 7
s_cselect_b32 s80, 21, 0
s_cselect_b32 s84, 54272, 0
s_add_u32 s80, s80, s71
s_mul_i32 s80, s80, 7168
s_add_u32 s80, s80, s60
s_add_u32 s84, s84, s61
s_lshl_b32 s85, s71, 10
s_add_u32 m0, s84, s85
s_nop 0
buffer_load_dwordx4 v16, s[44:47], s80 offen lds
s_add_u32 s71, s71, 1
s_cmp_eq_u32 s71, 14
s_cselect_b32 s71, 0, s71
s_cmp_ge_u32 s71, 7
s_cselect_b32 s80, 21, 0
s_cselect_b32 s84, 54272, 0
s_add_u32 s80, s80, s71
s_mul_i32 s80, s80, 7168
s_add_u32 s80, s80, s60
s_add_u32 s84, s84, s61
s_lshl_b32 s85, s71, 10
s_add_u32 m0, s84, s85
s_nop 0
buffer_load_dwordx4 v16, s[44:47], s80 offen lds
s_add_u32 s71, s71, 1
s_cmp_eq_u32 s71, 14
s_cselect_b32 s71, 0, s71
s_cmp_ge_u32 s71, 7
s_cselect_b32 s80, 21, 0
s_cselect_b32 s84, 54272, 0
s_add_u32 s80, s80, s71
s_mul_i32 s80, s80, 7168
s_add_u32 s80, s80, s60
s_add_u32 s84, s84, s61
s_lshl_b32 s85, s71, 10
s_add_u32 m0, s84, s85
s_nop 0
buffer_load_dwordx4 v16, s[44:47], s80 offen lds
s_waitcnt vmcnt(6)
s_mov_b64 exec, 1
ds_add_u32 v10, v11 offset:16
s_mov_b64 exec, -1
s_add_u32 s69, s69, 1
s_cmp_eq_u32 s69, 7
s_cselect_b32 s69, 0, s69
s_lshl_b32 s80, s69, 2
s_add_u32 s80, s80, s76
s_lshl_b32 s80, s80, 10
s_add_u32 m0, s80, 122880
s_lshl_b32 s81, s69, 7
s_add_u32 s81, s81, s70
buffer_load_dwordx4 v8, s[40:43], s81 offen lds
s_add_u32 s69, s69, 1
s_cmp_eq_u32 s69, 7
s_cselect_b32 s69, 0, s69
s_lshl_b32 s80, s69, 2
s_add_u32 s80, s80, s76
s_lshl_b32 s80, s80, 10
s_add_u32 m0, s80, 122880
s_lshl_b32 s81, s69, 7
s_add_u32 s81, s81, s70
buffer_load_dwordx4 v8, s[40:43], s81 offen lds
s_add_u32 s69, s69, 1
s_cmp_eq_u32 s69, 7
s_cselect_b32 s69, 0, s69
s_lshl_b32 s80, s69, 2
s_add_u32 s80, s80, s76
s_lshl_b32 s80, s80, 10
s_add_u32 m0, s80, 122880
s_lshl_b32 s81, s69, 7
s_add_u32 s81, s81, s70
buffer_load_dwordx4 v8, s[40:43], s81 offen lds
s_add_u32 s69, s69, 1
s_cmp_eq_u32 s69, 7
s_cselect_b32 s69, 0, s69
s_lshl_b32 s80, s69, 2
s_add_u32 s80, s80, s76
s_lshl_b32 s80, s80, 10
s_add_u32 m0, s80, 122880
s_lshl_b32 s81, s69, 7
s_add_u32 s81, s81, s70
buffer_load_dwordx4 v8, s[40:43], s81 offen lds
s_add_u32 s69, s69, 1
s_cmp_eq_u32 s69, 7
s_cselect_b32 s69, 0, s69
s_lshl_b32 s80, s69, 2
s_add_u32 s80, s80, s76
s_lshl_b32 s80, s80, 10
s_add_u32 m0, s80, 122880
s_lshl_b32 s81, s69, 7
s_add_u32 s81, s81, s70
buffer_load_dwordx4 v8, s[40:43], s81 offen lds
s_add_u32 s71, s71, 1
s_cmp_eq_u32 s71, 14
s_cselect_b32 s71, 0, s71
s_cmp_ge_u32 s71, 7
s_cselect_b32 s80, 21, 0
s_cselect_b32 s84, 54272, 0
s_add_u32 s80, s80, s71
s_mul_i32 s80, s80, 7168
s_add_u32 s80, s80, s60
s_add_u32 s84, s84, s61
s_lshl_b32 s85, s71, 10
s_add_u32 m0, s84, s85
s_nop 0
buffer_load_dwordx4 v16, s[44:47], s80 offen lds
s_add_u32 s71, s71, 1
s_cmp_eq_u32 s71, 14
s_cselect_b32 s71, 0, s71
s_cmp_ge_u32 s71, 7
s_cselect_b32 s80, 21, 0
s_cselect_b32 s84, 54272, 0
s_add_u32 s80, s80, s71
s_mul_i32 s80, s80, 7168
s_add_u32 s80, s80, s60
s_add_u32 s84, s84, s61
s_lshl_b32 s85, s71, 10
s_add_u32 m0, s84, s85
s_nop 0
buffer_load_dwordx4 v16, s[44:47], s80 offen lds
s_add_u32 s71, s71, 1
s_cmp_eq_u32 s71, 14
s_cselect_b32 s71, 0, s71
s_cmp_ge_u32 s71, 7
s_cselect_b32 s80, 21, 0
s_cselect_b32 s84, 54272, 0
s_add_u32 s80, s80, s71
s_mul_i32 s80, s80, 7168
s_add_u32 s80, s80, s60
s_add_u32 s84, s84, s61
s_lshl_b32 s85, s71, 10
s_add_u32 m0, s84, s85
s_nop 0
buffer_load_dwordx4 v16, s[44:47], s80 offen lds
s_add_u32 s71, s71, 1
s_cmp_eq_u32 s71, 14
s_cselect_b32 s71, 0, s71
s_cmp_ge_u32 s71, 7
s_cselect_b32 s80, 21, 0
s_cselect_b32 s84, 54272, 0
s_add_u32 s80, s80, s71
s_mul_i32 s80, s80, 7168
s_add_u32 s80, s80, s60
s_add_u32 s84, s84, s61
s_lshl_b32 s85, s71, 10
s_add_u32 m0, s84, s85
s_nop 0
buffer_load_dwordx4 v16, s[44:47], s80 offen lds
s_add_u32 s71, s71, 1
s_cmp_eq_u32 s71, 14
s_cselect_b32 s71, 0, s71
s_cmp_ge_u32 s71, 7
s_cselect_b32 s80, 21, 0
s_cselect_b32 s84, 54272, 0
s_add_u32 s80, s80, s71
s_mul_i32 s80, s80, 7168
s_add_u32 s80, s80, s60
s_add_u32 s84, s84, s61
s_lshl_b32 s85, s71, 10
s_add_u32 m0, s84, s85
s_nop 0
buffer_load_dwordx4 v16, s[44:47], s80 offen lds
s_add_u32 s71, s71, 1
s_cmp_eq_u32 s71, 14
s_cselect_b32 s71, 0, s71
s_cmp_ge_u32 s71, 7
s_cselect_b32 s80, 21, 0
s_cselect_b32 s84, 54272, 0
s_add_u32 s80, s80, s71
s_mul_i32 s80, s80, 7168
s_add_u32 s80, s80, s60
s_add_u32 s84, s84, s61
s_lshl_b32 s85, s71, 10
s_add_u32 m0, s84, s85
s_nop 0
buffer_load_dwordx4 v16, s[44:47], s80 offen lds
s_add_u32 s71, s71, 1
s_cmp_eq_u32 s71, 14
s_cselect_b32 s71, 0, s71
s_cmp_ge_u32 s71, 7
s_cselect_b32 s80, 21, 0
s_cselect_b32 s84, 54272, 0
s_add_u32 s80, s80, s71
s_mul_i32 s80, s80, 7168
s_add_u32 s80, s80, s60
s_add_u32 s84, s84, s61
s_lshl_b32 s85, s71, 10
s_add_u32 m0, s84, s85
s_nop 0
buffer_load_dwordx4 v16, s[44:47], s80 offen lds
s_add_u32 s71, s71, 1
s_cmp_eq_u32 s71, 14
s_cselect_b32 s71, 0, s71
s_cmp_ge_u32 s71, 7
s_cselect_b32 s80, 21, 0
s_cselect_b32 s84, 54272, 0
s_add_u32 s80, s80, s71
s_mul_i32 s80, s80, 7168
s_add_u32 s80, s80, s60
s_add_u32 s84, s84, s61
s_lshl_b32 s85, s71, 10
s_add_u32 m0, s84, s85
s_nop 0
buffer_load_dwordx4 v16, s[44:47], s80 offen lds
s_add_u32 s71, s71, 1
s_cmp_eq_u32 s71, 14
s_cselect_b32 s71, 0, s71
s_cmp_ge_u32 s71, 7
s_cselect_b32 s80, 21, 0
s_cselect_b32 s84, 54272, 0
s_add_u32 s80, s80, s71
s_mul_i32 s80, s80, 7168
s_add_u32 s80, s80, s60
s_add_u32 s84, s84, s61
s_lshl_b32 s85, s71, 10
s_add_u32 m0, s84, s85
s_nop 0
buffer_load_dwordx4 v16, s[44:47], s80 offen lds
s_add_u32 s71, s71, 1
s_cmp_eq_u32 s71, 14
s_cselect_b32 s71, 0, s71
s_cmp_ge_u32 s71, 7
s_cselect_b32 s80, 21, 0
s_cselect_b32 s84, 54272, 0
s_add_u32 s80, s80, s71
s_mul_i32 s80, s80, 7168
s_add_u32 s80, s80, s60
s_add_u32 s84, s84, s61
s_lshl_b32 s85, s71, 10
s_add_u32 m0, s84, s85
s_nop 0
buffer_load_dwordx4 v16, s[44:47], s80 offen lds
s_waitcnt vmcnt(10)
s_mov_b64 exec, 1
ds_add_u32 v10, v11 offset:48
s_mov_b64 exec, -1
Lw_8:
ds_read_b32 v12, v10 offset:68
s_sub_u32 s78, s78, 1
s_cbranch_scc1 LEND
s_waitcnt lgkmcnt(0)
v_readfirstlane_b32 s80, v12
s_nop 0
s_cmp_ge_u32 s80, 4
s_cbranch_scc0 Lw_8
s_mov_b32 s88, 255
s_mov_b32 s89, 255
s_add_u32 s84, s87, 0
buffer_load_dwordx4 v[20:23], v5, s[48:51], s84 offen offset:0 sc1
buffer_load_dwordx4 v[24:27], v5, s[48:51], s84 offen offset:256 sc1
s_add_u32 s84, s87, 8192
buffer_load_dwordx4 v[32:35], v5, s[48:51], s84 offen offset:0 sc1
buffer_load_dwordx4 v[36:39], v5, s[48:51], s84 offen offset:256 sc1
s_add_u32 s84, s87, 16384
buffer_load_dwordx4 v[40:43], v5, s[48:51], s84 offen offset:0 sc1
buffer_load_dwordx4 v[44:47], v5, s[48:51], s84 offen offset:256 sc1
s_add_u32 s84, s87, 24576
buffer_load_dwordx4 v[240:243], v5, s[48:51], s84 offen offset:0 sc1
buffer_load_dwordx4 v[244:247], v5, s[48:51], s84 offen offset:256 sc1
s_add_u32 s84, s87, 32768
buffer_load_dwordx4 v[248:251], v5, s[48:51], s84 offen offset:0 sc1
buffer_load_dwordx4 v[252:255], v5, s[48:51], s84 offen offset:256 sc1
s_add_u32 s84, s87, 40960
buffer_load_dwordx4 v[80:83], v5, s[48:51], s84 offen offset:0 sc1
buffer_load_dwordx4 v[84:87], v5, s[48:51], s84 offen offset:256 sc1
s_add_u32 s84, s87, 49152
buffer_load_dwordx4 v[88:91], v5, s[48:51], s84 offen offset:0 sc1
buffer_load_dwordx4 v[92:95], v5, s[48:51], s84 offen offset:256 sc1
s_add_u32 s84, s87, 57344
buffer_load_dwordx4 v[112:115], v5, s[48:51], s84 offen offset:0 sc1
buffer_load_dwordx4 v[116:119], v5, s[48:51], s84 offen offset:256 sc1
Lw_10:
ds_read_b32 v12, v10 offset:48
s_sub_u32 s78, s78, 1
s_cbranch_scc1 LEND
s_waitcnt lgkmcnt(0)
v_readfirstlane_b32 s80, v12
s_nop 0
s_cmp_ge_u32 s80, 4
s_cbranch_scc0 Lw_10
ds_read_b128 v[96:99], v48 offset:0
ds_read_b128 v[100:103], v49 offset:0
ds_read_b128 v[104:107], v50 offset:0
s_waitcnt lgkmcnt(2)
v_mfma_f32_32x32x16_bf16 v[64:79], v[96:99], v[128:131], 0
ds_read_b128 v[96:99], v51 offset:0
s_waitcnt lgkmcnt(2)
v_mfma_f32_32x32x16_bf16 v[64:79], v[100:103], v[132:135], v[64:79]
ds_read_b128 v[100:103], v52 offset:0
s_waitcnt lgkmcnt(2)
v_mfma_f32_32x32x16_bf16 v[64:79], v[104:107], v[136:139], v[64:79]
ds_read_b128 v[104:107], v53 offset:0
s_waitcnt lgkmcnt(2)
v_mfma_f32_32x32x16_bf16 v[64:79], v[96:99], v[140:143], v[64:79]
ds_read_b128 v[96:99], v54 offset:0
s_waitcnt lgkmcnt(2)
v_mfma_f32_32x32x16_bf16 v[64:79], v[100:103], v[144:147], v[64:79]
ds_read_b128 v[100:103], v55 offset:0
s_waitcnt lgkmcnt(2)
v_mfma_f32_32x32x16_bf16 v[64:79], v[104:107], v[148:151], v[64:79]
ds_read_b128 v[104:107], v48 offset:4096
s_waitcnt lgkmcnt(2)
v_mfma_f32_32x32x16_bf16 v[64:79], v[96:99], v[152:155], v[64:79]
ds_read_b128 v[96:99], v49 offset:4096
s_waitcnt lgkmcnt(2)
v_mfma_f32_32x32x16_bf16 v[64:79], v[100:103], v[156:159], v[64:79]
ds_read_b128 v[100:103], v50 offset:4096
s_waitcnt lgkmcnt(2)
v_mfma_f32_32x32x16_bf16 v[64:79], v[104:107], v[160:163], v[64:79]
ds_read_b128 v[104:107], v51 offset:4096
s_waitcnt lgkmcnt(2)
v_mfma_f32_32x32x16_bf16 v[64:79], v[96:99], v[164:167], v[64:79]
ds_read_b128 v[96:99], v52 offset:4096
s_waitcnt lgkmcnt(2)
v_mfma_f32_32x32x16_bf16 v[64:79], v[100:103], v[168:171], v[64:79]
ds_read_b128 v[100:103], v53 offset:4096
s_waitcnt lgkmcnt(2)
v_mfma_f32_32x32x16_bf16 v[64:79], v[104:107], v[172:175], v[64:79]
ds_read_b128 v[104:107], v54 offset:4096
s_waitcnt lgkmcnt(2)
v_mfma_f32_32x32x16_bf16 v[64:79], v[96:99], v[176:179], v[64:79]
ds_read_b128 v[96:99], v55 offset:4096
s_waitcnt lgkmcnt(2)
v_mfma_f32_32x32x16_bf16 v[64:79], v[100:103], v[180:183], v[64:79]
ds_read_b128 v[100:103], v48 offset:8192
s_waitcnt lgkmcnt(2)
v_mfma_f32_32x32x16_bf16 v[64:79], v[104:107], v[184:187], v[64:79]
ds_read_b128 v[104:107], v49 offset:8192
s_waitcnt lgkmcnt(2)
v_mfma_f32_32x32x16_bf16 v[64:79], v[96:99], v[188:191], v[64:79]
ds_read_b128 v[96:99], v50 offset:8192
s_waitcnt lgkmcnt(2)
v_mfma_f32_32x32x16_bf16 v[64:79], v[100:103], v[192:195], v[64:79]
ds_read_b128 v[100:103], v51 offset:8192
s_waitcnt lgkmcnt(2)
v_mfma_f32_32x32x16_bf16 v[64:79], v[104:107], v[196:199], v[64:79]
ds_read_b128 v[104:107], v52 offset:8192
s_waitcnt lgkmcnt(2)
v_mfma_f32_32x32x16_bf16 v[64:79], v[96:99], v[200:203], v[64:79]
ds_read_b128 v[96:99], v53 offset:8192
s_waitcnt lgkmcnt(2)
v_mfma_f32_32x32x16_bf16 v[64:79], v[100:103], v[204:207], v[64:79]
ds_read_b128 v[100:103], v54 offset:8192
s_waitcnt lgkmcnt(2)
v_mfma_f32_32x32x16_bf16 v[64:79], v[104:107], v[208:211], v[64:79]
ds_read_b128 v[104:107], v55 offset:8192
s_waitcnt lgkmcnt(2)
v_mfma_f32_32x32x16_bf16 v[64:79], v[96:99], v[212:215], v[64:79]
ds_read_b128 v[96:99], v48 offset:12288
s_waitcnt lgkmcnt(2)
v_mfma_f32_32x32x16_bf16 v[64:79], v[100:103], v[216:219], v[64:79]
ds_read_b128 v[100:103], v49 offset:12288
s_waitcnt lgkmcnt(2)
v_mfma_f32_32x32x16_bf16 v[64:79], v[104:107], v[220:223], v[64:79]
ds_read_b128 v[104:107], v50 offset:12288
s_waitcnt lgkmcnt(2)
v_mfma_f32_32x32x16_bf16 v[64:79], v[96:99], v[224:227], v[64:79]
ds_read_b128 v[96:99], v51 offset:12288
s_waitcnt lgkmcnt(2)
v_mfma_f32_32x32x16_bf16 v[64:79], v[100:103], v[228:231], v[64:79]
s_waitcnt lgkmcnt(1)
v_mfma_f32_32x32x16_bf16 v[64:79], v[104:107], v[232:235], v[64:79]
s_waitcnt lgkmcnt(0)
v_mfma_f32_32x32x16_bf16 v[64:79], v[96:99], v[236:239], v[64:79]
s_setprio 3
s_waitcnt vmcnt(14)
v_mfma_f32_16x16x32_bf16 v[120:123], v[124:127], v[20:23], v[120:123]
v_mfma_f32_16x16x32_bf16 v[108:111], v[124:127], v[24:27], v[108:111]
v_bitop3_b32 v7, v23, v27, v4 bitop3:0x7e
s_waitcnt vmcnt(12)
v_mfma_f32_16x16x32_bf16 v[120:123], v[124:127], v[32:35], v[120:123]
v_mfma_f32_16x16x32_bf16 v[108:111], v[124:127], v[36:39], v[108:111]
v_bitop3_b32 v7, v7, v35, v4 bitop3:0xf6
v_bitop3_b32 v7, v7, v39, v4 bitop3:0xf6
s_waitcnt vmcnt(10)
v_mfma_f32_16x16x32_bf16 v[120:123], v[124:127], v[40:43], v[120:123]
v_mfma_f32_16x16x32_bf16 v[108:111], v[124:127], v[44:47], v[108:111]
v_bitop3_b32 v7, v7, v43, v4 bitop3:0xf6
v_bitop3_b32 v7, v7, v47, v4 bitop3:0xf6
s_waitcnt vmcnt(8)
v_mfma_f32_16x16x32_bf16 v[120:123], v[124:127], v[240:243], v[120:123]
v_mfma_f32_16x16x32_bf16 v[108:111], v[124:127], v[244:247], v[108:111]
v_bitop3_b32 v7, v7, v243, v4 bitop3:0xf6
v_bitop3_b32 v7, v7, v247, v4 bitop3:0xf6
s_waitcnt vmcnt(6)
v_mfma_f32_16x16x32_bf16 v[120:123], v[124:127], v[248:251], v[120:123]
v_mfma_f32_16x16x32_bf16 v[108:111], v[124:127], v[252:255], v[108:111]
v_bitop3_b32 v7, v7, v251, v4 bitop3:0xf6
v_bitop3_b32 v7, v7, v255, v4 bitop3:0xf6
s_waitcnt vmcnt(4)
v_mfma_f32_16x16x32_bf16 v[120:123], v[124:127], v[80:83], v[120:123]
v_mfma_f32_16x16x32_bf16 v[108:111], v[124:127], v[84:87], v[108:111]
v_bitop3_b32 v7, v7, v83, v4 bitop3:0xf6
v_bitop3_b32 v7, v7, v87, v4 bitop3:0xf6
s_waitcnt vmcnt(2)
v_mfma_f32_16x16x32_bf16 v[120:123], v[124:127], v[88:91], v[120:123]
v_mfma_f32_16x16x32_bf16 v[108:111], v[124:127], v[92:95], v[108:111]
v_bitop3_b32 v7, v7, v91, v4 bitop3:0xf6
v_bitop3_b32 v7, v7, v95, v4 bitop3:0xf6
s_waitcnt vmcnt(0)
v_mfma_f32_16x16x32_bf16 v[120:123], v[124:127], v[112:115], v[120:123]
v_mfma_f32_16x16x32_bf16 v[108:111], v[124:127], v[116:119], v[108:111]
v_bitop3_b32 v7, v7, v115, v4 bitop3:0xf6
v_bitop3_b32 v7, v7, v119, v4 bitop3:0xf6
v_cmp_lt_u32 vcc, s86, v7
s_cbranch_vccz Lga_9x
s_nop 7
v_mov_b32 v120, 0
v_mov_b32 v121, 0
v_mov_b32 v122, 0
v_mov_b32 v123, 0
v_mov_b32 v108, 0
v_mov_b32 v109, 0
v_mov_b32 v110, 0
v_mov_b32 v111, 0
s_bitcmp1_b32 s89, 0
s_cbranch_scc0 Lga_9bc0
v_bitop3_b32 v7, v23, v27, v4 bitop3:0x7e
v_cmp_lt_u32 vcc, s86, v7
s_cbranch_vccnz Lga_9bc0
v_mfma_f32_16x16x32_bf16 v[120:123], v[124:127], v[20:23], v[120:123]
v_mfma_f32_16x16x32_bf16 v[108:111], v[124:127], v[24:27], v[108:111]
s_bitset0_b32 s88, 0
Lga_9bc0:
s_bitcmp1_b32 s89, 1
s_cbranch_scc0 Lga_9bc1
v_bitop3_b32 v7, v35, v39, v4 bitop3:0x7e
v_cmp_lt_u32 vcc, s86, v7
s_cbranch_vccnz Lga_9bc1
v_mfma_f32_16x16x32_bf16 v[120:123], v[124:127], v[32:35], v[120:123]
v_mfma_f32_16x16x32_bf16 v[108:111], v[124:127], v[36:39], v[108:111]
s_bitset0_b32 s88, 1
Lga_9bc1:
s_bitcmp1_b32 s89, 2
s_cbranch_scc0 Lga_9bc2
v_bitop3_b32 v7, v43, v47, v4 bitop3:0x7e
v_cmp_lt_u32 vcc, s86, v7
s_cbranch_vccnz Lga_9bc2
v_mfma_f32_16x16x32_bf16 v[120:123], v[124:127], v[40:43], v[120:123]
v_mfma_f32_16x16x32_bf16 v[108:111], v[124:127], v[44:47], v[108:111]
s_bitset0_b32 s88, 2
Lga_9bc2:
s_bitcmp1_b32 s89, 3
s_cbranch_scc0 Lga_9bc3
v_bitop3_b32 v7, v243, v247, v4 bitop3:0x7e
v_cmp_lt_u32 vcc, s86, v7
s_cbranch_vccnz Lga_9bc3
v_mfma_f32_16x16x32_bf16 v[120:123], v[124:127], v[240:243], v[120:123]
v_mfma_f32_16x16x32_bf16 v[108:111], v[124:127], v[244:247], v[108:111]
s_bitset0_b32 s88, 3
Lga_9bc3:
s_bitcmp1_b32 s89, 4
s_cbranch_scc0 Lga_9bc4
v_bitop3_b32 v7, v251, v255, v4 bitop3:0x7e
v_cmp_lt_u32 vcc, s86, v7
s_cbranch_vccnz Lga_9bc4
v_mfma_f32_16x16x32_bf16 v[120:123], v[124:127], v[248:251], v[120:123]
v_mfma_f32_16x16x32_bf16 v[108:111], v[124:127], v[252:255], v[108:111]
s_bitset0_b32 s88, 4
Lga_9bc4:
s_bitcmp1_b32 s89, 5
s_cbranch_scc0 Lga_9bc5
v_bitop3_b32 v7, v83, v87, v4 bitop3:0x7e
v_cmp_lt_u32 vcc, s86, v7
s_cbranch_vccnz Lga_9bc5
v_mfma_f32_16x16x32_bf16 v[120:123], v[124:127], v[80:83], v[120:123]
v_mfma_f32_16x16x32_bf16 v[108:111], v[124:127], v[84:87], v[108:111]
s_bitset0_b32 s88, 5
Lga_9bc5:
s_bitcmp1_b32 s89, 6
s_cbranch_scc0 Lga_9bc6
v_bitop3_b32 v7, v91, v95, v4 bitop3:0x7e
v_cmp_lt_u32 vcc, s86, v7
s_cbranch_vccnz Lga_9bc6
v_mfma_f32_16x16x32_bf16 v[120:123], v[124:127], v[88:91], v[120:123]
v_mfma_f32_16x16x32_bf16 v[108:111], v[124:127], v[92:95], v[108:111]
s_bitset0_b32 s88, 6
Lga_9bc6:
s_bitcmp1_b32 s89, 7
s_cbranch_scc0 Lga_9bc7
v_bitop3_b32 v7, v115, v119, v4 bitop3:0x7e
v_cmp_lt_u32 vcc, s86, v7
s_cbranch_vccnz Lga_9bc7
v_mfma_f32_16x16x32_bf16 v[120:123], v[124:127], v[112:115], v[120:123]
v_mfma_f32_16x16x32_bf16 v[108:111], v[124:127], v[116:119], v[108:111]
s_bitset0_b32 s88, 7
Lga_9bc7:
Lga_9r:
s_cmp_eq_u32 s88, 0
s_cbranch_scc1 Lga_9x
s_sleep 4
s_sub_u32 s78, s78, 8
s_cbranch_scc1 LEND
s_waitcnt vmcnt(0)
s_mov_b32 s89, s88
s_bitcmp1_b32 s89, 0
s_cbranch_scc0 Lga_9di0
s_add_u32 s84, s87, 0
buffer_load_dwordx4 v[20:23], v5, s[48:51], s84 offen offset:0 sc1
buffer_load_dwordx4 v[24:27], v5, s[48:51], s84 offen offset:256 sc1
Lga_9di0:
s_bitcmp1_b32 s89, 1
s_cbranch_scc0 Lga_9di1
s_add_u32 s84, s87, 8192
buffer_load_dwordx4 v[32:35], v5, s[48:51], s84 offen offset:0 sc1
buffer_load_dwordx4 v[36:39], v5, s[48:51], s84 offen offset:256 sc1
Lga_9di1:
s_bitcmp1_b32 s89, 2
s_cbranch_scc0 Lga_9di2
s_add_u32 s84, s87, 16384
buffer_load_dwordx4 v[40:43], v5, s[48:51], s84 offen offset:0 sc1
buffer_load_dwordx4 v[44:47], v5, s[48:51], s84 offen offset:256 sc1
Lga_9di2:
s_bitcmp1_b32 s89, 3
s_cbranch_scc0 Lga_9di3
s_add_u32 s84, s87, 24576
buffer_load_dwordx4 v[240:243], v5, s[48:51], s84 offen offset:0 sc1
buffer_load_dwordx4 v[244:247], v5, s[48:51], s84 offen offset:256 sc1
Lga_9di3:
s_bitcmp1_b32 s89, 4
s_cbranch_scc0 Lga_9di4
s_add_u32 s84, s87, 32768
buffer_load_dwordx4 v[248:251], v5, s[48:51], s84 offen offset:0 sc1
buffer_load_dwordx4 v[252:255], v5, s[48:51], s84 offen offset:256 sc1
Lga_9di4:
s_bitcmp1_b32 s89, 5
s_cbranch_scc0 Lga_9di5
s_add_u32 s84, s87, 40960
buffer_load_dwordx4 v[80:83], v5, s[48:51], s84 offen offset:0 sc1
buffer_load_dwordx4 v[84:87], v5, s[48:51], s84 offen offset:256 sc1
Lga_9di5:
s_bitcmp1_b32 s89, 6
s_cbranch_scc0 Lga_9di6
s_add_u32 s84, s87, 49152
buffer_load_dwordx4 v[88:91], v5, s[48:51], s84 offen offset:0 sc1
buffer_load_dwordx4 v[92:95], v5, s[48:51], s84 offen offset:256 sc1
Lga_9di6:
s_bitcmp1_b32 s89, 7
s_cbranch_scc0 Lga_9di7
s_add_u32 s84, s87, 57344
buffer_load_dwordx4 v[112:115], v5, s[48:51], s84 offen offset:0 sc1
buffer_load_dwordx4 v[116:119], v5, s[48:51], s84 offen offset:256 sc1
Lga_9di7:
s_waitcnt vmcnt(0)
s_bitcmp1_b32 s89, 0
s_cbranch_scc0 Lga_9ec0
v_bitop3_b32 v7, v23, v27, v4 bitop3:0x7e
v_cmp_lt_u32 vcc, s86, v7
s_cbranch_vccnz Lga_9ec0
v_mfma_f32_16x16x32_bf16 v[120:123], v[124:127], v[20:23], v[120:123]
v_mfma_f32_16x16x32_bf16 v[108:111], v[124:127], v[24:27], v[108:111]
s_bitset0_b32 s88, 0
Lga_9ec0:
s_bitcmp1_b32 s89, 1
s_cbranch_scc0 Lga_9ec1
v_bitop3_b32 v7, v35, v39, v4 bitop3:0x7e
v_cmp_lt_u32 vcc, s86, v7
s_cbranch_vccnz Lga_9ec1
v_mfma_f32_16x16x32_bf16 v[120:123], v[124:127], v[32:35], v[120:123]
v_mfma_f32_16x16x32_bf16 v[108:111], v[124:127], v[36:39], v[108:111]
s_bitset0_b32 s88, 1
Lga_9ec1:
s_bitcmp1_b32 s89, 2
s_cbranch_scc0 Lga_9ec2
v_bitop3_b32 v7, v43, v47, v4 bitop3:0x7e
v_cmp_lt_u32 vcc, s86, v7
s_cbranch_vccnz Lga_9ec2
v_mfma_f32_16x16x32_bf16 v[120:123], v[124:127], v[40:43], v[120:123]
v_mfma_f32_16x16x32_bf16 v[108:111], v[124:127], v[44:47], v[108:111]
s_bitset0_b32 s88, 2
Lga_9ec2:
s_bitcmp1_b32 s89, 3
s_cbranch_scc0 Lga_9ec3
v_bitop3_b32 v7, v243, v247, v4 bitop3:0x7e
v_cmp_lt_u32 vcc, s86, v7
s_cbranch_vccnz Lga_9ec3
v_mfma_f32_16x16x32_bf16 v[120:123], v[124:127], v[240:243], v[120:123]
v_mfma_f32_16x16x32_bf16 v[108:111], v[124:127], v[244:247], v[108:111]
s_bitset0_b32 s88, 3
Lga_9ec3:
s_bitcmp1_b32 s89, 4
s_cbranch_scc0 Lga_9ec4
v_bitop3_b32 v7, v251, v255, v4 bitop3:0x7e
v_cmp_lt_u32 vcc, s86, v7
s_cbranch_vccnz Lga_9ec4
v_mfma_f32_16x16x32_bf16 v[120:123], v[124:127], v[248:251], v[120:123]
v_mfma_f32_16x16x32_bf16 v[108:111], v[124:127], v[252:255], v[108:111]
s_bitset0_b32 s88, 4
Lga_9ec4:
s_bitcmp1_b32 s89, 5
s_cbranch_scc0 Lga_9ec5
v_bitop3_b32 v7, v83, v87, v4 bitop3:0x7e
v_cmp_lt_u32 vcc, s86, v7
s_cbranch_vccnz Lga_9ec5
v_mfma_f32_16x16x32_bf16 v[120:123], v[124:127], v[80:83], v[120:123]
v_mfma_f32_16x16x32_bf16 v[108:111], v[124:127], v[84:87], v[108:111]
s_bitset0_b32 s88, 5
Lga_9ec5:
s_bitcmp1_b32 s89, 6
s_cbranch_scc0 Lga_9ec6
v_bitop3_b32 v7, v91, v95, v4 bitop3:0x7e
v_cmp_lt_u32 vcc, s86, v7
s_cbranch_vccnz Lga_9ec6
v_mfma_f32_16x16x32_bf16 v[120:123], v[124:127], v[88:91], v[120:123]
v_mfma_f32_16x16x32_bf16 v[108:111], v[124:127], v[92:95], v[108:111]
s_bitset0_b32 s88, 6
Lga_9ec6:
s_bitcmp1_b32 s89, 7
s_cbranch_scc0 Lga_9ec7
v_bitop3_b32 v7, v115, v119, v4 bitop3:0x7e
v_cmp_lt_u32 vcc, s86, v7
s_cbranch_vccnz Lga_9ec7
v_mfma_f32_16x16x32_bf16 v[120:123], v[124:127], v[112:115], v[120:123]
v_mfma_f32_16x16x32_bf16 v[108:111], v[124:127], v[116:119], v[108:111]
s_bitset0_b32 s88, 7
Lga_9ec7:
s_branch Lga_9r
Lga_9x:
s_nop 7
v_cvt_pk_bf16_f32 v80, v120, v121
v_cvt_pk_bf16_f32 v81, v122, v123
v_cvt_pk_bf16_f32 v82, v108, v109
v_cvt_pk_bf16_f32 v83, v110, v111
ds_write_b64 v6, v[80:81]
ds_write_b64 v6, v[82:83] offset:256
s_waitcnt lgkmcnt(0)
s_mov_b64 exec, 1
ds_add_u32 v10, v11 offset:4
s_mov_b64 exec, -1
s_setprio 0
s_mov_b64 exec, 1
ds_add_u32 v10, v11 offset:20
s_mov_b64 exec, -1
global_load_dwordx4 v[20:23], v9, s[6:7] offset:0
global_load_dwordx4 v[24:27], v9, s[6:7] offset:1024
s_mov_b64 exec, 1
ds_add_u32 v10, v11 offset:52
s_mov_b64 exec, -1
s_waitcnt vmcnt(0)
v_cvt_pk_bf16_f32 v80, v64, v65
v_cvt_pk_bf16_f32 v81, v66, v67
v_cvt_pk_bf16_f32 v82, v68, v69
v_cvt_pk_bf16_f32 v83, v70, v71
v_cvt_pk_bf16_f32 v84, v72, v73
v_cvt_pk_bf16_f32 v85, v74, v75
v_cvt_pk_bf16_f32 v86, v76, v77
v_cvt_pk_bf16_f32 v87, v78, v79
v_mfma_f32_32x32x16_bf16 v[64:79], v[80:83], v[20:23], 0
s_nop 0
v_mfma_f32_32x32x16_bf16 v[64:79], v[84:87], v[24:27], v[64:79]
Lw_11:
ds_read_b32 v12, v10 offset:52
s_sub_u32 s78, s78, 1
s_cbranch_scc1 LEND
s_waitcnt lgkmcnt(0)
v_readfirstlane_b32 s80, v12
s_nop 0
s_cmp_ge_u32 s80, 4
s_cbranch_scc0 Lw_11
s_nop 7
v_cvt_pk_bf16_f32 v80, v64, v65
v_cvt_pk_bf16_f32 v81, v66, v67
v_cvt_pk_bf16_f32 v82, v68, v69
v_cvt_pk_bf16_f32 v83, v70, v71
v_cvt_pk_bf16_f32 v84, v72, v73
v_cvt_pk_bf16_f32 v85, v74, v75
v_cvt_pk_bf16_f32 v86, v76, v77
v_cvt_pk_bf16_f32 v87, v78, v79
ds_write_b64 v56, v[80:81]
ds_write_b64 v57, v[82:83]
ds_write_b64 v58, v[84:85]
ds_write_b64 v59, v[86:87]
s_waitcnt lgkmcnt(0)
ds_read_b128 v[96:99], v60
ds_read_b128 v[100:103], v60 offset:1024
v_and_b32 v1, 3, v0
v_lshlrev_b32 v1, 3, v1
v_lshrrev_b32 v1, v1, v13
s_mov_b32 s80, 0x00010001
v_bfe_u32 v12, v1, 0, 2
v_mul_u32_u24 v12, 0x8001, v12
v_and_b32 v104, s80, v12
v_bfe_u32 v12, v1, 2, 2
v_mul_u32_u24 v12, 0x8001, v12
v_and_b32 v105, s80, v12
v_bfe_u32 v12, v1, 4, 2
v_mul_u32_u24 v12, 0x8001, v12
v_and_b32 v106, s80, v12
v_bfe_u32 v12, v1, 6, 2
v_mul_u32_u24 v12, 0x8001, v12
v_and_b32 v107, s80, v12
s_waitcnt lgkmcnt(0)
v_lshrrev_b32 v12, 1, v96
v_bitop3_b32 v12, v12, v96, s80 bitop3:0x80
v_add_u32 v96, v96, v12
v_bfi_b32 v96, s80, v104, v96
v_lshrrev_b32 v12, 1, v97
v_bitop3_b32 v12, v12, v97, s80 bitop3:0x80
v_add_u32 v97, v97, v12
v_bfi_b32 v97, s80, v105, v97
v_lshrrev_b32 v12, 1, v98
v_bitop3_b32 v12, v12, v98, s80 bitop3:0x80
v_add_u32 v98, v98, v12
v_bfi_b32 v98, s80, v106, v98
v_lshrrev_b32 v12, 1, v99
v_bitop3_b32 v12, v12, v99, s80 bitop3:0x80
v_add_u32 v99, v99, v12
v_bfi_b32 v99, s80, v107, v99
v_lshrrev_b32 v12, 1, v100
v_bitop3_b32 v12, v12, v100, s80 bitop3:0x80
v_add_u32 v100, v100, v12
v_bfi_b32 v100, s80, v104, v100
v_lshrrev_b32 v12, 1, v101
v_bitop3_b32 v12, v12, v101, s80 bitop3:0x80
v_add_u32 v101, v101, v12
v_bfi_b32 v101, s80, v105, v101
v_lshrrev_b32 v12, 1, v102
v_bitop3_b32 v12, v12, v102, s80 bitop3:0x80
v_add_u32 v102, v102, v12
v_bfi_b32 v102, s80, v106, v102
v_lshrrev_b32 v12, 1, v103
v_bitop3_b32 v12, v12, v103, s80 bitop3:0x80
v_add_u32 v103, v103, v12
v_bfi_b32 v103, s80, v107, v103
buffer_store_dwordx4 v[96:99], v61, s[48:51], s66 offen sc1
buffer_store_dwordx4 v[100:103], v61, s[48:51], s67 offen sc1
s_mov_b64 exec, 1
ds_add_u32 v10, v11 offset:36
s_mov_b64 exec, -1
s_lshr_b32 s64, s73, 4
s_lshl_b32 s80, s72, 1
s_add_u32 s64, s64, s80
s_lshr_b32 s4, s73, 2
s_and_b32 s4, s4, 3
s_and_b32 s65, s73, 3
s_cmp_lt_u32 s65, 2
s_cselect_b32 s84, 16, -992
s_cmp_eq_u32 s64, 0
s_cselect_b32 s84, s84, s64
s_lshl_b32 s80, s65, 9
s_add_u32 s80, s80, s84
v_and_b32 v1, 15, v0
v_lshlrev_b32 v1, 5, v1
v_add_u32 v28, s80, v1
v_cvt_f32_u32 v30, v28
v_mul_f32 v30, 0x3a000000, v30
v_lshrrev_b32 v1, 4, v0
v_lshlrev_b32 v1, 3, v1
v_cvt_f32_u32 v1, v1
v_mul_f32 v31, v30, v1
s_mov_b32 s84, 0x80008000
s_mov_b32 s80, 0x41c00000
v_cos_f32 v248, v31
v_sin_f32 v250, -v31
v_add_f32 v31, v31, v30
v_cos_f32 v249, v31
v_sin_f32 v251, -v31
v_add_f32 v31, v31, v30
v_cvt_pk_bf16_f32 v32, v248, v249
v_cvt_pk_bf16_f32 v40, v250, v251
v_xor_b32 v240, s84, v40
v_cos_f32 v248, v31
v_sin_f32 v250, -v31
v_add_f32 v31, v31, v30
v_cos_f32 v249, v31
v_sin_f32 v251, -v31
v_add_f32 v31, v31, v30
v_cvt_pk_bf16_f32 v33, v248, v249
v_cvt_pk_bf16_f32 v41, v250, v251
v_xor_b32 v241, s84, v41
v_cos_f32 v248, v31
v_sin_f32 v250, -v31
v_add_f32 v31, v31, v30
v_cos_f32 v249, v31
v_sin_f32 v251, -v31
v_add_f32 v31, v31, v30
v_cvt_pk_bf16_f32 v34, v248, v249
v_cvt_pk_bf16_f32 v42, v250, v251
v_xor_b32 v242, s84, v42
v_cos_f32 v248, v31
v_sin_f32 v250, -v31
v_add_f32 v31, v31, v30
v_cos_f32 v249, v31
v_sin_f32 v251, -v31
v_add_f32 v31, v31, v30
v_cvt_pk_bf16_f32 v35, v248, v249
v_cvt_pk_bf16_f32 v43, v250, v251
v_xor_b32 v243, s84, v43
v_fma_f32 v31, v30, s80, v31
v_cos_f32 v248, v31
v_sin_f32 v250, -v31
v_add_f32 v31, v31, v30
v_cos_f32 v249, v31
v_sin_f32 v251, -v31
v_add_f32 v31, v31, v30
v_cvt_pk_bf16_f32 v36, v248, v249
v_cvt_pk_bf16_f32 v44, v250, v251
v_xor_b32 v244, s84, v44
v_cos_f32 v248, v31
v_sin_f32 v250, -v31
v_add_f32 v31, v31, v30
v_cos_f32 v249, v31
v_sin_f32 v251, -v31
v_add_f32 v31, v31, v30
v_cvt_pk_bf16_f32 v37, v248, v249
v_cvt_pk_bf16_f32 v45, v250, v251
v_xor_b32 v245, s84, v45
v_cos_f32 v248, v31
v_sin_f32 v250, -v31
v_add_f32 v31, v31, v30
v_cos_f32 v249, v31
v_sin_f32 v251, -v31
v_add_f32 v31, v31, v30
v_cvt_pk_bf16_f32 v38, v248, v249
v_cvt_pk_bf16_f32 v46, v250, v251
v_xor_b32 v246, s84, v46
v_cos_f32 v248, v31
v_sin_f32 v250, -v31
v_add_f32 v31, v31, v30
v_cos_f32 v249, v31
v_sin_f32 v251, -v31
v_add_f32 v31, v31, v30
v_cvt_pk_bf16_f32 v39, v248, v249
v_cvt_pk_bf16_f32 v47, v250, v251
v_xor_b32 v247, s84, v47
v_and_b32 v1, 15, v0
v_lshlrev_b32 v48, 8, v1
v_and_b32 v1, 7, v1
v_lshrrev_b32 v12, 5, v0
s_lshl_b32 s80, s76, 1
v_add_u32 v12, s80, v12
v_xor_b32 v12, v12, v1
v_lshl_add_u32 v48, v12, 4, v48
v_bfe_u32 v12, v0, 4, 1
v_lshl_add_u32 v48, v12, 3, v48
v_add_u32 v48, 32768, v48
v_xor_b32 v49, 248, v48
v_lshrrev_b32 v1, 3, v0
v_and_b32 v12, 7, v0
v_xor_b32 v14, v12, v1
v_lshlrev_b32 v52, 8, v1
v_lshl_add_u32 v52, v14, 4, v52
s_lshl_b32 s80, s76, 11
s_add_u32 s80, s80, 32768
v_add_u32 v52, s80, v52
v_readfirstlane_b32 s80, v28
s_and_b32 s84, s76, 1
s_lshl_b32 s84, s84, 8
s_add_u32 s80, s80, s84
v_lshl_add_u32 v1, v1, 5, s80
v_sub_u32 v14, 2048, v1
s_cmp_ge_u32 s76, 2
s_cselect_b64 vcc, -1, 0
v_cndmask_b32 v1, v1, v14, vcc
v_mul_u32_u24 v1, 1792, v1
v_lshl_add_u32 v1, v12, 4, v1
s_lshl_b32 s80, s4, 7
v_add_u32 v53, s80, v1
s_sub_u32 s80, 770, s80
v_add_u32 v54, s80, v1
s_lshl_b32 s62, s64, 2
s_add_u32 s62, s62, s4
s_lshl_b32 s62, s62, 2
s_add_u32 s62, s62, s76
s_lshl_b32 s62, s62, 13
s_add_u32 s62, s62, 4202496
s_add_u32 s63, s62, 4096
s_lshl_b32 s81, s76, 13
s_add_u32 s81, s81, 122880
v_add_u32 v62, s81, v9
v_lshrrev_b32 v1, 4, v0
v_bfe_u32 v12, v0, 2, 2
v_lshl_add_u32 v14, v1, 3, v12
v_lshlrev_b32 v63, 7, v14
v_and_b32 v1, 1, v1
v_lshlrev_b32 v1, 1, v1
v_lshrrev_b32 v12, 1, v12
v_or_b32 v1, v1, v12
v_xor_b32 v1, s76, v1
v_lshl_add_u32 v63, v1, 5, v63
v_and_b32 v1, 3, v0
v_lshl_add_u32 v63, v1, 3, v63
v_add_u32 v63, 122880, v63
v_bfe_u32 v12, v0, 4, 1
v_lshlrev_b32 v12, 1, v12
v_and_b32 v1, 3, v0
v_xor_b32 v1, v1, v12
v_lshlrev_b32 v1, 3, v1
v_lshrrev_b32 v1, v1, v13
s_mov_b32 s85, 0x00010001
v_bfe_u32 v12, v1, 0, 2
v_mul_u32_u24 v12, 0x8001, v12
v_and_b32 v104, s85, v12
v_bfe_u32 v12, v1, 2, 2
v_mul_u32_u24 v12, 0x8001, v12
v_and_b32 v105, s85, v12
v_bfe_u32 v12, v1, 4, 2
v_mul_u32_u24 v12, 0x8001, v12
v_and_b32 v106, s85, v12
v_bfe_u32 v12, v1, 6, 2
v_mul_u32_u24 v12, 0x8001, v12
v_and_b32 v107, s85, v12
Lw_12:
ds_read_b32 v12, v10 offset:36
s_sub_u32 s78, s78, 1
s_cbranch_scc1 LEND
s_waitcnt lgkmcnt(0)
v_readfirstlane_b32 s80, v12
s_nop 0
s_cmp_ge_u32 s80, 4
s_cbranch_scc0 Lw_12
Lw_13:
ds_read_b32 v12, v10 offset:56
s_sub_u32 s78, s78, 1
s_cbranch_scc1 LEND
s_waitcnt lgkmcnt(0)
v_readfirstlane_b32 s80, v12
s_nop 0
s_cmp_ge_u32 s80, 4
s_cbranch_scc0 Lw_13
s_sleep 8
Lul_14:
buffer_load_dwordx4 v[192:195], v9, s[48:51], s62 offen offset:0 sc1
buffer_load_dwordx4 v[196:199], v9, s[48:51], s62 offen offset:1024 sc1
buffer_load_dwordx4 v[200:203], v9, s[48:51], s62 offen offset:2048 sc1
buffer_load_dwordx4 v[204:207], v9, s[48:51], s62 offen offset:3072 sc1
buffer_load_dwordx4 v[208:211], v9, s[48:51], s63 offen offset:0 sc1
buffer_load_dwordx4 v[212:215], v9, s[48:51], s63 offen offset:1024 sc1
buffer_load_dwordx4 v[216:219], v9, s[48:51], s63 offen offset:2048 sc1
buffer_load_dwordx4 v[220:223], v9, s[48:51], s63 offen offset:3072 sc1
s_waitcnt vmcnt(7)
v_xor_b32 v192, v192, v104
v_xor_b32 v193, v193, v105
v_xor_b32 v194, v194, v106
v_xor_b32 v195, v195, v107
ds_write_b128 v62, v[192:195] offset:0
v_or3_b32 v12, v192, v193, v194
v_or_b32 v7, v12, v195
s_waitcnt vmcnt(6)
v_xor_b32 v196, v196, v104
v_xor_b32 v197, v197, v105
v_xor_b32 v198, v198, v106
v_xor_b32 v199, v199, v107
ds_write_b128 v62, v[196:199] offset:1024
v_or3_b32 v12, v196, v197, v198
v_or3_b32 v7, v7, v12, v199
s_waitcnt vmcnt(5)
v_xor_b32 v200, v200, v104
v_xor_b32 v201, v201, v105
v_xor_b32 v202, v202, v106
v_xor_b32 v203, v203, v107
ds_write_b128 v62, v[200:203] offset:2048
v_or3_b32 v12, v200, v201, v202
v_or3_b32 v7, v7, v12, v203
s_waitcnt vmcnt(4)
v_xor_b32 v204, v204, v104
v_xor_b32 v205, v205, v105
v_xor_b32 v206, v206, v106
v_xor_b32 v207, v207, v107
ds_write_b128 v62, v[204:207] offset:3072
v_or3_b32 v12, v204, v205, v206
v_or3_b32 v7, v7, v12, v207
s_waitcnt vmcnt(3)
v_xor_b32 v208, v208, v104
v_xor_b32 v209, v209, v105
v_xor_b32 v210, v210, v106
v_xor_b32 v211, v211, v107
ds_write_b128 v62, v[208:211] offset:4096
v_or3_b32 v12, v208, v209, v210
v_or3_b32 v7, v7, v12, v211
s_waitcnt vmcnt(2)
v_xor_b32 v212, v212, v104
v_xor_b32 v213, v213, v105
v_xor_b32 v214, v214, v106
v_xor_b32 v215, v215, v107
ds_write_b128 v62, v[212:215] offset:5120
v_or3_b32 v12, v212, v213, v214
v_or3_b32 v7, v7, v12, v215
s_waitcnt vmcnt(1)
v_xor_b32 v216, v216, v104
v_xor_b32 v217, v217, v105
v_xor_b32 v218, v218, v106
v_xor_b32 v219, v219, v107
ds_write_b128 v62, v[216:219] offset:6144
v_or3_b32 v12, v216, v217, v218
v_or3_b32 v7, v7, v12, v219
s_waitcnt vmcnt(0)
v_xor_b32 v220, v220, v104
v_xor_b32 v221, v221, v105
v_xor_b32 v222, v222, v106
v_xor_b32 v223, v223, v107
ds_write_b128 v62, v[220:223] offset:7168
v_or3_b32 v12, v220, v221, v222
v_or3_b32 v7, v7, v12, v223
v_and_b32 v7, s85, v7
v_cmp_ne_u32 vcc, 0, v7
s_cbranch_vccz Lul_14x
Lul_14r:
s_mov_b32 s88, 0
s_waitcnt lgkmcnt(0)
v_or3_b32 v7, v192, v193, v194
v_or_b32 v7, v7, v195
v_and_b32 v7, s85, v7
v_cmp_ne_u32 vcc, 0, v7
s_cbranch_vccz Lul_14k0
buffer_load_dwordx4 v[192:195], v9, s[48:51], s62 offen offset:0 sc1
s_bitset1_b32 s88, 0
Lul_14k0:
v_or3_b32 v7, v196, v197, v198
v_or_b32 v7, v7, v199
v_and_b32 v7, s85, v7
v_cmp_ne_u32 vcc, 0, v7
s_cbranch_vccz Lul_14k1
buffer_load_dwordx4 v[196:199], v9, s[48:51], s62 offen offset:1024 sc1
s_bitset1_b32 s88, 1
Lul_14k1:
v_or3_b32 v7, v200, v201, v202
v_or_b32 v7, v7, v203
v_and_b32 v7, s85, v7
v_cmp_ne_u32 vcc, 0, v7
s_cbranch_vccz Lul_14k2
buffer_load_dwordx4 v[200:203], v9, s[48:51], s62 offen offset:2048 sc1
s_bitset1_b32 s88, 2
Lul_14k2:
v_or3_b32 v7, v204, v205, v206
v_or_b32 v7, v7, v207
v_and_b32 v7, s85, v7
v_cmp_ne_u32 vcc, 0, v7
s_cbranch_vccz Lul_14k3
buffer_load_dwordx4 v[204:207], v9, s[48:51], s62 offen offset:3072 sc1
s_bitset1_b32 s88, 3
Lul_14k3:
v_or3_b32 v7, v208, v209, v210
v_or_b32 v7, v7, v211
v_and_b32 v7, s85, v7
v_cmp_ne_u32 vcc, 0, v7
s_cbranch_vccz Lul_14k4
buffer_load_dwordx4 v[208:211], v9, s[48:51], s63 offen offset:0 sc1
s_bitset1_b32 s88, 4
Lul_14k4:
v_or3_b32 v7, v212, v213, v214
v_or_b32 v7, v7, v215
v_and_b32 v7, s85, v7
v_cmp_ne_u32 vcc, 0, v7
s_cbranch_vccz Lul_14k5
buffer_load_dwordx4 v[212:215], v9, s[48:51], s63 offen offset:1024 sc1
s_bitset1_b32 s88, 5
Lul_14k5:
v_or3_b32 v7, v216, v217, v218
v_or_b32 v7, v7, v219
v_and_b32 v7, s85, v7
v_cmp_ne_u32 vcc, 0, v7
s_cbranch_vccz Lul_14k6
buffer_load_dwordx4 v[216:219], v9, s[48:51], s63 offen offset:2048 sc1
s_bitset1_b32 s88, 6
Lul_14k6:
v_or3_b32 v7, v220, v221, v222
v_or_b32 v7, v7, v223
v_and_b32 v7, s85, v7
v_cmp_ne_u32 vcc, 0, v7
s_cbranch_vccz Lul_14k7
buffer_load_dwordx4 v[220:223], v9, s[48:51], s63 offen offset:3072 sc1
s_bitset1_b32 s88, 7
Lul_14k7:
s_cmp_eq_u32 s88, 0
s_cbranch_scc1 Lul_14w
s_waitcnt vmcnt(0)
s_bitcmp1_b32 s88, 0
s_cbranch_scc0 Lul_14m0
v_xor_b32 v192, v192, v104
v_xor_b32 v193, v193, v105
v_xor_b32 v194, v194, v106
v_xor_b32 v195, v195, v107
Lul_14m0:
s_bitcmp1_b32 s88, 1
s_cbranch_scc0 Lul_14m1
v_xor_b32 v196, v196, v104
v_xor_b32 v197, v197, v105
v_xor_b32 v198, v198, v106
v_xor_b32 v199, v199, v107
Lul_14m1:
s_bitcmp1_b32 s88, 2
s_cbranch_scc0 Lul_14m2
v_xor_b32 v200, v200, v104
v_xor_b32 v201, v201, v105
v_xor_b32 v202, v202, v106
v_xor_b32 v203, v203, v107
Lul_14m2:
s_bitcmp1_b32 s88, 3
s_cbranch_scc0 Lul_14m3
v_xor_b32 v204, v204, v104
v_xor_b32 v205, v205, v105
v_xor_b32 v206, v206, v106
v_xor_b32 v207, v207, v107
Lul_14m3:
s_bitcmp1_b32 s88, 4
s_cbranch_scc0 Lul_14m4
v_xor_b32 v208, v208, v104
v_xor_b32 v209, v209, v105
v_xor_b32 v210, v210, v106
v_xor_b32 v211, v211, v107
Lul_14m4:
s_bitcmp1_b32 s88, 5
s_cbranch_scc0 Lul_14m5
v_xor_b32 v212, v212, v104
v_xor_b32 v213, v213, v105
v_xor_b32 v214, v214, v106
v_xor_b32 v215, v215, v107
Lul_14m5:
s_bitcmp1_b32 s88, 6
s_cbranch_scc0 Lul_14m6
v_xor_b32 v216, v216, v104
v_xor_b32 v217, v217, v105
v_xor_b32 v218, v218, v106
v_xor_b32 v219, v219, v107
Lul_14m6:
s_bitcmp1_b32 s88, 7
s_cbranch_scc0 Lul_14m7
v_xor_b32 v220, v220, v104
v_xor_b32 v221, v221, v105
v_xor_b32 v222, v222, v106
v_xor_b32 v223, v223, v107
Lul_14m7:
s_sleep 4
s_sub_u32 s78, s78, 8
s_cbranch_scc0 Lul_14r
s_branch LEND
Lul_14w:
ds_write_b128 v62, v[192:195] offset:0
ds_write_b128 v62, v[196:199] offset:1024
ds_write_b128 v62, v[200:203] offset:2048
ds_write_b128 v62, v[204:207] offset:3072
ds_write_b128 v62, v[208:211] offset:4096
ds_write_b128 v62, v[212:215] offset:5120
ds_write_b128 v62, v[216:219] offset:6144
ds_write_b128 v62, v[220:223] offset:7168
Lul_14x:
s_waitcnt lgkmcnt(0)
s_mov_b64 exec, 1
ds_add_u32 v10, v11 offset:28
s_mov_b64 exec, -1
Lw_15:
ds_read_b32 v12, v10 offset:12
s_sub_u32 s78, s78, 1
s_cbranch_scc1 LEND
s_waitcnt lgkmcnt(0)
v_readfirstlane_b32 s80, v12
s_nop 0
s_cmp_ge_u32 s80, 4
s_cbranch_scc0 Lw_15
Lw_16:
ds_read_b32 v12, v10 offset:28
s_sub_u32 s78, s78, 1
s_cbranch_scc1 LEND
s_waitcnt lgkmcnt(0)
v_readfirstlane_b32 s80, v12
s_nop 0
s_cmp_ge_u32 s80, 4
s_cbranch_scc0 Lw_16
ds_read_b64_tr_b16 v[168:169], v63 offset:0
ds_read_b64_tr_b16 v[170:171], v63 offset:512
ds_read_b64_tr_b16 v[172:173], v63 offset:4096
ds_read_b64_tr_b16 v[174:175], v63 offset:4608
ds_read_b64_tr_b16 v[176:177], v63 offset:8192
ds_read_b64_tr_b16 v[178:179], v63 offset:8704
ds_read_b64_tr_b16 v[180:181], v63 offset:12288
ds_read_b64_tr_b16 v[182:183], v63 offset:12800
ds_read_b64_tr_b16 v[184:185], v63 offset:16384
ds_read_b64_tr_b16 v[186:187], v63 offset:16896
ds_read_b64_tr_b16 v[188:189], v63 offset:20480
ds_read_b64_tr_b16 v[190:191], v63 offset:20992
ds_read_b64_tr_b16 v[192:193], v63 offset:24576
ds_read_b64_tr_b16 v[194:195], v63 offset:25088
ds_read_b64_tr_b16 v[196:197], v63 offset:28672
ds_read_b64_tr_b16 v[198:199], v63 offset:29184
s_cmp_lg_u32 s64, 0
s_cbranch_scc1 Lcls_17g
s_waitcnt lgkmcnt(0)
s_cmp_lt_u32 s65, 2
s_cbranch_scc1 Lcls_17h
v_mfma_f32_16x16x32_bf16 v[64:67], v[168:171], v[32:35], 0
v_mfma_f32_16x16x32_bf16 v[68:71], v[184:187], v[40:43], 0
v_mfma_f32_16x16x32_bf16 v[64:67], v[172:175], v[36:39], v[64:67]
v_mfma_f32_16x16x32_bf16 v[68:71], v[188:191], v[44:47], v[68:71]
s_branch Lcls_17x
Lcls_17h:
v_mfma_f32_16x16x32_bf16 v[64:67], v[176:179], v[32:35], 0
v_mfma_f32_16x16x32_bf16 v[68:71], v[192:195], v[40:43], 0
v_mfma_f32_16x16x32_bf16 v[64:67], v[180:183], v[36:39], v[64:67]
v_mfma_f32_16x16x32_bf16 v[68:71], v[196:199], v[44:47], v[68:71]
s_branch Lcls_17x
Lcls_17g:
s_waitcnt lgkmcnt(12)
v_mfma_f32_16x16x32_bf16 v[64:67], v[168:171], v[32:35], 0
v_mfma_f32_16x16x32_bf16 v[64:67], v[172:175], v[36:39], v[64:67]
s_waitcnt lgkmcnt(8)
v_mfma_f32_16x16x32_bf16 v[64:67], v[176:179], v[240:243], v[64:67]
v_mfma_f32_16x16x32_bf16 v[64:67], v[180:183], v[244:247], v[64:67]
s_waitcnt lgkmcnt(4)
v_mfma_f32_16x16x32_bf16 v[68:71], v[184:187], v[40:43], 0
v_mfma_f32_16x16x32_bf16 v[68:71], v[188:191], v[44:47], v[68:71]
s_waitcnt lgkmcnt(0)
v_mfma_f32_16x16x32_bf16 v[68:71], v[192:195], v[32:35], v[68:71]
v_mfma_f32_16x16x32_bf16 v[68:71], v[196:199], v[36:39], v[68:71]
Lcls_17x:
s_nop 7
v_sub_f32 v76, v64, v68
v_add_f32 v80, v64, v68
v_sub_f32 v77, v65, v69
v_add_f32 v81, v65, v69
v_sub_f32 v78, v66, v70
v_add_f32 v82, v66, v70
v_sub_f32 v79, v67, v71
v_add_f32 v83, v67, v71
v_cvt_pk_bf16_f32 v84, v76, v77
v_cvt_pk_bf16_f32 v85, v78, v79
v_cvt_pk_bf16_f32 v86, v80, v81
v_cvt_pk_bf16_f32 v87, v82, v83
v_cvt_pk_bf16_f32 v88, v79, v78
v_cvt_pk_bf16_f32 v89, v77, v76
v_cvt_pk_bf16_f32 v90, v83, v82
v_cvt_pk_bf16_f32 v91, v81, v80
ds_write_b64 v48, v[84:85]
ds_write_b64 v48, v[86:87] offset:4096
ds_write_b64 v49, v[90:91]
ds_write_b64 v49, v[88:89] offset:4096
s_waitcnt lgkmcnt(0)
s_mov_b64 exec, 1
ds_add_u32 v10, v11 offset:60
s_mov_b64 exec, -1
s_or_b32 s80, s64, s65
s_cmp_lg_u32 s80, 0
s_cbranch_scc1 Lz_18
v_mov_b32 v240, 0x3f803f80
v_mov_b32 v241, 0x3f803f80
v_mov_b32 v242, 0x3f803f80
v_mov_b32 v243, 0x3f803f80
s_nop 1
v_mfma_f32_16x16x32_bf16 v[72:75], v[168:171], v[240:243], 0
v_mfma_f32_16x16x32_bf16 v[72:75], v[172:175], v[240:243], v[72:75]
s_lshl_b32 s81, s4, 6
s_lshl_b32 s82, s76, 4
s_add_u32 s81, s81, s82
v_lshrrev_b32 v1, 4, v0
v_lshl_add_u32 v55, v1, 2, s81
s_mov_b32 s14, 0x00010001
s_mov_b32 s15, 0x00010001
s_movk_i32 s81, 220
s_movk_i32 s82, 224
v_cmp_ge_u32 s[8:9], s81, v55
v_cmp_lt_u32 vcc, 0, v55
s_and_b64 s[8:9], s[8:9], s[14:15]
s_and_b64 s[10:11], s[8:9], vcc
v_cmp_eq_u32 s[12:13], s82, v55
s_nop 0
s_and_b64 s[12:13], s[12:13], s[14:15]
v_lshlrev_b32 v56, 1, v55
v_sub_u32 v57, 890, v56
v_cvt_pk_bf16_f32 v92, v72, v73
v_cvt_pk_bf16_f32 v93, v74, v75
v_cvt_pk_bf16_f32 v94, v75, v72
v_cvt_pk_bf16_f32 v95, v74, v73
s_mov_b64 exec, s[8:9]
buffer_store_dwordx2 v[92:93], v56, s[52:55], 0 offen
buffer_store_short v94, v57, s[52:55], 0 offen
buffer_store_dword v95, v57, s[52:55], 0 offen offset:2
s_mov_b64 exec, s[10:11]
buffer_store_short_d16_hi v94, v57, s[52:55], 0 offen offset:6
s_mov_b64 exec, s[12:13]
buffer_store_short v92, v56, s[52:55], 0 offen
s_mov_b64 exec, -1
Lz_18:
Lw_19:
ds_read_b32 v12, v10 offset:60
s_sub_u32 s78, s78, 1
s_cbranch_scc1 LEND
s_waitcnt lgkmcnt(0)
v_readfirstlane_b32 s80, v12
s_nop 0
s_cmp_ge_u32 s80, 4
s_cbranch_scc0 Lw_19
ds_read_b128 v[84:87], v52
ds_read_b128 v[88:91], v52 offset:128
s_cmp_eq_u32 s4, 3
s_cbranch_scc1 Ly_203
s_waitcnt lgkmcnt(1)
buffer_store_dwordx4 v[84:87], v53, s[52:55], 0 offen
s_waitcnt lgkmcnt(0)
s_cmp_eq_u32 s4, 0
s_cbranch_scc1 Ly_200
buffer_store_dwordx4 v[88:91], v54, s[52:55], 0 offen
s_branch Ly_20x
Ly_200:
s_mov_b32 exec_lo, 0x7f7f7f7f
s_mov_b32 exec_hi, 0x7f7f7f7f
buffer_store_dwordx4 v[88:91], v54, s[52:55], 0 offen
s_mov_b32 exec_lo, 0x80808080
s_mov_b32 exec_hi, 0x80808080
buffer_store_dwordx3 v[88:90], v54, s[52:55], 0 offen
buffer_store_short v91, v54, s[52:55], 0 offen offset:12
s_branch Ly_20x
Ly_203:
s_waitcnt lgkmcnt(0)
s_mov_b32 exec_lo, 0x0f0f0f0f
s_mov_b32 exec_hi, 0x0f0f0f0f
buffer_store_dwordx4 v[84:87], v53, s[52:55], 0 offen
s_mov_b32 exec_lo, 0x10101010
s_mov_b32 exec_hi, 0x10101010
buffer_store_short v84, v53, s[52:55], 0 offen
s_mov_b32 exec_lo, 0xf0f0f0f0
s_mov_b32 exec_hi, 0xf0f0f0f0
buffer_store_dwordx4 v[88:91], v54, s[52:55], 0 offen
Ly_20x:
s_mov_b64 exec, -1
s_endpgm
LB:
s_getpc_b64 s[4:5]
Lpc_21:
s_sub_u32 s4, s4, Lpc_21-concat_heads__spectral_fnet__linear_kernel_hedgehog__prompt_kernel
s_subb_u32 s5, s5, 0
s_lshl_b32 s80, s76, 13
v_lshl_add_u32 v1, v0, 7, s80
v_min_u32 v1, LTAB-concat_heads__spectral_fnet__linear_kernel_hedgehog__prompt_kernel+2048-4, v1
global_load_dword v252, v1, s[4:5]
v_lshlrev_b32 v9, 4, v0
s_and_b32 s80, s76, 1
s_lshl_b32 s80, s80, 10
s_add_u32 m0, s80, 155904
s_mul_i32 s81, s74, 1568
s_add_u32 s81, s81, s80
s_waitcnt lgkmcnt(0)
s_mov_b32 s56, s22
s_mov_b32 s57, s23
s_mov_b32 s58, 25088
s_mov_b32 s59, 0x20000
buffer_load_dwordx4 v9, s[56:59], s81 offen lds
v_mov_b32 v108, 0
s_mov_b32 s86, 0x3fb8aa3b
s_mov_b32 s87, 0xbfb8aa3b
s_mov_b32 s88, 0xffff0000
s_mov_b32 s89, 0xffff
v_and_b32 v7, 31, v0
v_lshrrev_b32 v8, 5, v0
v_bfe_u32 v12, v0, 1, 3
s_lshl_b32 s80, s76, 12
s_add_u32 s80, s80, 57344
v_xor_b32 v13, v12, v8
v_lshlrev_b32 v13, 4, v13
v_lshl_add_u32 v13, v7, 7, v13
v_add_u32 v13, s80, v13
v_xor_b32 v2, 0, v13
v_xor_b32 v3, 32, v13
v_xor_b32 v4, 64, v13
v_xor_b32 v5, 96, v13
s_lshl_b32 s80, s76, 12
s_add_u32 s80, s80, 57344
v_xor_b32 v13, v12, v8
v_lshlrev_b32 v13, 3, v13
v_lshl_add_u32 v13, v7, 6, v13
v_add_u32 v13, s80, v13
v_xor_b32 v112, 0, v13
v_xor_b32 v113, 16, v13
v_xor_b32 v114, 32, v13
v_xor_b32 v115, 48, v13
v_lshrrev_b32 v122, 4, v0
v_bfe_u32 v123, v0, 2, 2
v_and_b32 v124, 3, v0
v_lshl_add_u32 v13, v8, 3, v123
v_lshlrev_b32 v13, 6, v13
v_lshl_add_u32 v13, v124, 3, v13
v_and_b32 v12, 1, v122
v_lshl_add_u32 v6, v12, 5, v13
v_lshlrev_b32 v12, 2, v12
v_lshrrev_b32 v13, 1, v123
v_add_u32 v12, v12, v13
v_xor_b32 v12, v12, v124
v_lshlrev_b32 v12, 3, v12
v_lshl_add_u32 v13, v122, 3, v123
v_lshl_add_u32 v12, v13, 6, v12
v_add_u32 v118, 73728, v12
v_add_u32 v119, 256, v118
v_xor_b32 v119, 16, v119
v_xor_b32 v120, 32, v118
v_xor_b32 v121, 32, v119
s_and_b32 s80, s76, 1
s_lshl_b32 s80, s80, 5
s_lshr_b32 s81, s76, 1
s_lshl_b32 s81, s81, 11
s_sub_u32 s81, 16384, s81
v_xor_b32 v116, s80, v118
v_subrev_u32 v116, s81, v116
v_xor_b32 v117, s80, v119
v_subrev_u32 v117, s81, v117
v_and_b32 v12, 15, v0
v_lshlrev_b32 v12, 4, v12
v_and_b32 v13, 1, v122
v_lshl_add_u32 v12, v13, 9, v12
v_lshl_add_u32 v125, v8, 8, v12
v_lshl_add_u32 v126, v8, 12, v12
v_lshl_add_u32 v127, v8, 3, v12
s_lshl_b32 s80, s76, 10
s_add_u32 s80, s80, 159744
v_add_u32 v127, s80, v127
s_mov_b32 s48, s30
s_mov_b32 s49, s31
s_mov_b32 s50, 268435456
s_mov_b32 s51, 0x20000
s_mov_b32 s52, s26
s_mov_b32 s53, s27
s_mov_b32 s54, 3670016
s_mov_b32 s55, 0x20000
s_lshl_b32 s92, s74, 4
s_add_u32 s92, s92, s75
s_lshl_b32 s92, s92, 2
s_add_u32 s92, s92, s76
s_lshl_b32 s92, s92, 10
s_add_u32 s92, s92, 4096
s_lshl_b32 s94, s75, 2
s_add_u32 s94, s94, s76
s_lshl_b32 s94, s94, 4
s_add_u32 s94, s94, s74
s_lshl_b32 s94, s94, 11
s_add_u32 s94, s94, 2101248
s_lshl_b32 s93, s74, 16
s_lshl_b32 s80, s76, 10
s_add_u32 s93, s93, s80
s_add_u32 s93, s93, 4096
s_lshl_b32 s81, s72, 2
s_lshr_b32 s80, s73, 3
s_add_u32 s81, s81, s80
s_lshl_b32 s95, s81, 2
s_add_u32 s95, s95, s76
s_lshl_b32 s95, s95, 14
s_add_u32 s95, s95, 2101248
s_lshl_b32 s81, s81, 1
s_lshr_b32 s80, s76, 1
s_add_u32 s81, s81, s80
s_mul_i32 s96, s81, 57344
s_and_b32 s3, s73, 7
s_lshl_b32 s81, s3, 1
s_and_b32 s80, s76, 1
s_add_u32 s81, s81, s80
s_lshl_b32 s81, s81, 6
s_add_u32 s96, s96, s81
s_add_u32 s96, s96, 896
v_lshrrev_b32 v12, 4, v7
v_and_b32 v13, 15, v0
v_add_u32 v13, 4, v13
v_lshrrev_b32 v13, 4, v13
v_lshl_add_u32 v13, v12, 1, v13
v_sub_u32 v104, v7, v13
v_and_b32 v13, 11, v0
v_add_u32 v12, 28, v12
v_cmp_eq_u32 vcc, 11, v13
s_nop 1
v_cndmask_b32 v104, v104, v12, vcc
v_lshl_add_u32 v100, v8, 2, v123
v_sub_u32 v12, v100, v8
v_add_u32 v101, 8, v12
v_add_u32 v102, 14, v100
v_add_u32 v103, 22, v12
v_min_u32 v103, 27, v103
v_lshlrev_b32 v105, 4, v104
v_lshl_add_u32 v105, v8, 9, v105
v_add_u32 v105, 159744, v105
v_and_b32 v13, 1, v122
v_lshlrev_b32 v13, 5, v13
v_lshl_add_u32 v13, v124, 3, v13
s_and_b32 s80, s76, 1
v_add_u32 v13, 28672, v13
v_bfe_u32 v12, v100, 1, 1
v_xor_b32 v12, s80, v12
v_lshl_add_u32 v12, v12, 6, v13
v_lshl_add_u32 v100, v100, 7, v12
v_bfe_u32 v12, v101, 1, 1
v_xor_b32 v12, s80, v12
v_lshl_add_u32 v12, v12, 6, v13
v_lshl_add_u32 v101, v101, 7, v12
v_bfe_u32 v12, v102, 1, 1
v_xor_b32 v12, s80, v12
v_lshl_add_u32 v12, v12, 6, v13
v_lshl_add_u32 v102, v102, 7, v12
v_bfe_u32 v12, v103, 1, 1
v_xor_b32 v12, s80, v12
v_lshl_add_u32 v12, v12, 6, v13
v_lshl_add_u32 v103, v103, 7, v12
v_min_u32 v12, 27, v104
v_mul_u32_u24 v13, 224, v8
v_lshl_add_u32 v106, v12, 1, v13
v_add_u32 v106, 155904, v106
s_waitcnt vmcnt(0)
s_setprio 2
s_barrier
ds_read_b128 v[128:131], v2 offset:0
ds_read_b64_tr_b16 v[48:49], v6 offset:0
ds_read_b64_tr_b16 v[50:51], v6 offset:256
ds_read_b64_tr_b16 v[52:53], v6 offset:4096
ds_read_b64_tr_b16 v[54:55], v6 offset:4352
ds_read_b128 v[132:135], v3 offset:0
ds_read_b64_tr_b16 v[56:57], v6 offset:1024
ds_read_b64_tr_b16 v[58:59], v6 offset:1280
ds_read_b64_tr_b16 v[60:61], v6 offset:5120
ds_read_b64_tr_b16 v[62:63], v6 offset:5376
ds_read_b128 v[136:139], v4 offset:0
ds_read_b64_tr_b16 v[64:65], v6 offset:2048
ds_read_b64_tr_b16 v[66:67], v6 offset:2304
ds_read_b64_tr_b16 v[68:69], v6 offset:6144
ds_read_b64_tr_b16 v[70:71], v6 offset:6400
ds_read_b128 v[140:143], v5 offset:0
ds_read_b64_tr_b16 v[72:73], v6 offset:3072
ds_read_b64_tr_b16 v[74:75], v6 offset:3328
ds_read_b64_tr_b16 v[76:77], v6 offset:7168
ds_read_b64_tr_b16 v[78:79], v6 offset:7424
s_waitcnt lgkmcnt(15)
v_mfma_f32_32x32x16_bf16 v[16:31], v[48:51], v[128:131], 0
v_mfma_f32_32x32x16_bf16 v[32:47], v[52:55], v[128:131], 0
s_waitcnt lgkmcnt(10)
v_mfma_f32_32x32x16_bf16 v[16:31], v[56:59], v[132:135], v[16:31]
v_mfma_f32_32x32x16_bf16 v[32:47], v[60:63], v[132:135], v[32:47]
s_waitcnt lgkmcnt(5)
v_mfma_f32_32x32x16_bf16 v[16:31], v[64:67], v[136:139], v[16:31]
v_mfma_f32_32x32x16_bf16 v[32:47], v[68:71], v[136:139], v[32:47]
s_waitcnt lgkmcnt(0)
v_mfma_f32_32x32x16_bf16 v[16:31], v[72:75], v[140:143], v[16:31]
v_mfma_f32_32x32x16_bf16 v[32:47], v[76:79], v[140:143], v[32:47]
ds_read_u16 v240, v106 offset:0
ds_read_u16 v241, v106 offset:56
ds_read_u16 v242, v106 offset:112
ds_read_u16 v243, v106 offset:168
ds_read_u16 v244, v106 offset:448
ds_read_u16 v245, v106 offset:504
ds_read_u16 v246, v106 offset:560
ds_read_u16 v247, v106 offset:616
ds_read_u16 v248, v106 offset:896
ds_read_u16 v249, v106 offset:952
ds_read_u16 v250, v106 offset:1008
ds_read_u16 v251, v106 offset:1064
ds_read_u16 v252, v106 offset:1344
ds_read_u16 v253, v106 offset:1400
ds_read_u16 v254, v106 offset:1456
ds_read_u16 v255, v106 offset:1512
s_waitcnt lgkmcnt(0)
v_lshl_or_b32 v80, v241, 16, v240
v_lshl_or_b32 v81, v243, 16, v242
v_lshl_or_b32 v82, v245, 16, v244
v_lshl_or_b32 v83, v247, 16, v246
v_lshl_or_b32 v84, v249, 16, v248
v_lshl_or_b32 v85, v251, 16, v250
v_lshl_or_b32 v86, v253, 16, v252
v_lshl_or_b32 v87, v255, 16, v254
s_mov_b32 exec_lo, 0
v_mov_b32 v86, 0
v_mov_b32 v87, 0
s_mov_b32 exec_lo, -1
s_barrier
ds_read_b128 v[144:147], v2 offset:16384
ds_read_b64_tr_b16 v[48:49], v6 offset:8192
ds_read_b64_tr_b16 v[50:51], v6 offset:8448
ds_read_b64_tr_b16 v[52:53], v6 offset:12288
ds_read_b64_tr_b16 v[54:55], v6 offset:12544
ds_read_b128 v[148:151], v3 offset:16384
ds_read_b64_tr_b16 v[56:57], v6 offset:9216
ds_read_b64_tr_b16 v[58:59], v6 offset:9472
ds_read_b64_tr_b16 v[60:61], v6 offset:13312
ds_read_b64_tr_b16 v[62:63], v6 offset:13568
ds_read_b128 v[152:155], v4 offset:16384
ds_read_b64_tr_b16 v[64:65], v6 offset:10240
ds_read_b64_tr_b16 v[66:67], v6 offset:10496
ds_read_b64_tr_b16 v[68:69], v6 offset:14336
ds_read_b64_tr_b16 v[70:71], v6 offset:14592
ds_read_b128 v[156:159], v5 offset:16384
ds_read_b64_tr_b16 v[72:73], v6 offset:11264
ds_read_b64_tr_b16 v[74:75], v6 offset:11520
ds_read_b64_tr_b16 v[76:77], v6 offset:15360
ds_read_b64_tr_b16 v[78:79], v6 offset:15616
s_waitcnt lgkmcnt(15)
v_mfma_f32_32x32x16_bf16 v[16:31], v[48:51], v[144:147], v[16:31]
v_mfma_f32_32x32x16_bf16 v[32:47], v[52:55], v[144:147], v[32:47]
s_waitcnt lgkmcnt(10)
v_mfma_f32_32x32x16_bf16 v[16:31], v[56:59], v[148:151], v[16:31]
v_mfma_f32_32x32x16_bf16 v[32:47], v[60:63], v[148:151], v[32:47]
s_waitcnt lgkmcnt(5)
v_mfma_f32_32x32x16_bf16 v[16:31], v[64:67], v[152:155], v[16:31]
v_mfma_f32_32x32x16_bf16 v[32:47], v[68:71], v[152:155], v[32:47]
s_waitcnt lgkmcnt(0)
v_mfma_f32_32x32x16_bf16 v[16:31], v[72:75], v[156:159], v[16:31]
v_mfma_f32_32x32x16_bf16 v[32:47], v[76:79], v[156:159], v[32:47]
s_barrier
ds_read_b128 v[160:163], v2 offset:32768
ds_read_b64_tr_b16 v[48:49], v6 offset:16384
ds_read_b64_tr_b16 v[50:51], v6 offset:16640
ds_read_b64_tr_b16 v[52:53], v6 offset:20480
ds_read_b64_tr_b16 v[54:55], v6 offset:20736
ds_read_b128 v[164:167], v3 offset:32768
ds_read_b64_tr_b16 v[56:57], v6 offset:17408
ds_read_b64_tr_b16 v[58:59], v6 offset:17664
ds_read_b64_tr_b16 v[60:61], v6 offset:21504
ds_read_b64_tr_b16 v[62:63], v6 offset:21760
ds_read_b128 v[168:171], v4 offset:32768
ds_read_b64_tr_b16 v[64:65], v6 offset:18432
ds_read_b64_tr_b16 v[66:67], v6 offset:18688
ds_read_b64_tr_b16 v[68:69], v6 offset:22528
ds_read_b64_tr_b16 v[70:71], v6 offset:22784
ds_read_b128 v[172:175], v5 offset:32768
ds_read_b64_tr_b16 v[72:73], v6 offset:19456
ds_read_b64_tr_b16 v[74:75], v6 offset:19712
ds_read_b64_tr_b16 v[76:77], v6 offset:23552
ds_read_b64_tr_b16 v[78:79], v6 offset:23808
s_waitcnt lgkmcnt(15)
v_mfma_f32_32x32x16_bf16 v[16:31], v[48:51], v[160:163], v[16:31]
v_mfma_f32_32x32x16_bf16 v[32:47], v[52:55], v[160:163], v[32:47]
s_waitcnt lgkmcnt(10)
v_mfma_f32_32x32x16_bf16 v[16:31], v[56:59], v[164:167], v[16:31]
v_mfma_f32_32x32x16_bf16 v[32:47], v[60:63], v[164:167], v[32:47]
s_waitcnt lgkmcnt(5)
v_mfma_f32_32x32x16_bf16 v[16:31], v[64:67], v[168:171], v[16:31]
v_mfma_f32_32x32x16_bf16 v[32:47], v[68:71], v[168:171], v[32:47]
s_waitcnt lgkmcnt(0)
v_mfma_f32_32x32x16_bf16 v[16:31], v[72:75], v[172:175], v[16:31]
v_mfma_f32_32x32x16_bf16 v[32:47], v[76:79], v[172:175], v[32:47]
s_barrier
ds_read_b128 v[176:179], v2 offset:49152
ds_read_b64_tr_b16 v[48:49], v6 offset:24576
ds_read_b64_tr_b16 v[50:51], v6 offset:24832
ds_read_b64_tr_b16 v[52:53], v6 offset:28672
ds_read_b64_tr_b16 v[54:55], v6 offset:28928
ds_read_b128 v[180:183], v3 offset:49152
ds_read_b64_tr_b16 v[56:57], v6 offset:25600
ds_read_b64_tr_b16 v[58:59], v6 offset:25856
ds_read_b64_tr_b16 v[60:61], v6 offset:29696
ds_read_b64_tr_b16 v[62:63], v6 offset:29952
ds_read_b128 v[184:187], v4 offset:49152
ds_read_b64_tr_b16 v[64:65], v6 offset:26624
ds_read_b64_tr_b16 v[66:67], v6 offset:26880
ds_read_b64_tr_b16 v[68:69], v6 offset:30720
ds_read_b64_tr_b16 v[70:71], v6 offset:30976
ds_read_b128 v[188:191], v5 offset:49152
ds_read_b64_tr_b16 v[72:73], v6 offset:27648
ds_read_b64_tr_b16 v[74:75], v6 offset:27904
ds_read_b64_tr_b16 v[76:77], v6 offset:31744
ds_read_b64_tr_b16 v[78:79], v6 offset:32000
s_waitcnt lgkmcnt(15)
v_mfma_f32_32x32x16_bf16 v[16:31], v[48:51], v[176:179], v[16:31]
v_mfma_f32_32x32x16_bf16 v[32:47], v[52:55], v[176:179], v[32:47]
s_waitcnt lgkmcnt(10)
v_mfma_f32_32x32x16_bf16 v[16:31], v[56:59], v[180:183], v[16:31]
v_mfma_f32_32x32x16_bf16 v[32:47], v[60:63], v[180:183], v[32:47]
s_waitcnt lgkmcnt(5)
v_mfma_f32_32x32x16_bf16 v[16:31], v[64:67], v[184:187], v[16:31]
v_mfma_f32_32x32x16_bf16 v[32:47], v[68:71], v[184:187], v[32:47]
s_waitcnt lgkmcnt(0)
v_mfma_f32_32x32x16_bf16 v[16:31], v[72:75], v[188:191], v[16:31]
v_mfma_f32_32x32x16_bf16 v[32:47], v[76:79], v[188:191], v[32:47]
s_barrier
ds_read_b128 v[192:195], v2 offset:0
ds_read_b64_tr_b16 v[48:49], v6 offset:32768
ds_read_b64_tr_b16 v[50:51], v6 offset:33024
ds_read_b64_tr_b16 v[52:53], v6 offset:36864
ds_read_b64_tr_b16 v[54:55], v6 offset:37120
ds_read_b128 v[196:199], v3 offset:0
ds_read_b64_tr_b16 v[56:57], v6 offset:33792
ds_read_b64_tr_b16 v[58:59], v6 offset:34048
ds_read_b64_tr_b16 v[60:61], v6 offset:37888
ds_read_b64_tr_b16 v[62:63], v6 offset:38144
ds_read_b128 v[200:203], v4 offset:0
ds_read_b64_tr_b16 v[64:65], v6 offset:34816
ds_read_b64_tr_b16 v[66:67], v6 offset:35072
ds_read_b64_tr_b16 v[68:69], v6 offset:38912
ds_read_b64_tr_b16 v[70:71], v6 offset:39168
ds_read_b128 v[204:207], v5 offset:0
ds_read_b64_tr_b16 v[72:73], v6 offset:35840
ds_read_b64_tr_b16 v[74:75], v6 offset:36096
ds_read_b64_tr_b16 v[76:77], v6 offset:39936
ds_read_b64_tr_b16 v[78:79], v6 offset:40192
s_waitcnt lgkmcnt(15)
v_mfma_f32_32x32x16_bf16 v[16:31], v[48:51], v[192:195], v[16:31]
v_mfma_f32_32x32x16_bf16 v[32:47], v[52:55], v[192:195], v[32:47]
s_waitcnt lgkmcnt(10)
v_mfma_f32_32x32x16_bf16 v[16:31], v[56:59], v[196:199], v[16:31]
v_mfma_f32_32x32x16_bf16 v[32:47], v[60:63], v[196:199], v[32:47]
s_waitcnt lgkmcnt(5)
v_mfma_f32_32x32x16_bf16 v[16:31], v[64:67], v[200:203], v[16:31]
v_mfma_f32_32x32x16_bf16 v[32:47], v[68:71], v[200:203], v[32:47]
s_waitcnt lgkmcnt(0)
v_mfma_f32_32x32x16_bf16 v[16:31], v[72:75], v[204:207], v[16:31]
v_mfma_f32_32x32x16_bf16 v[32:47], v[76:79], v[204:207], v[32:47]
s_barrier
ds_read_b128 v[208:211], v2 offset:16384
ds_read_b64_tr_b16 v[48:49], v6 offset:40960
ds_read_b64_tr_b16 v[50:51], v6 offset:41216
ds_read_b64_tr_b16 v[52:53], v6 offset:45056
ds_read_b64_tr_b16 v[54:55], v6 offset:45312
ds_read_b128 v[212:215], v3 offset:16384
ds_read_b64_tr_b16 v[56:57], v6 offset:41984
ds_read_b64_tr_b16 v[58:59], v6 offset:42240
ds_read_b64_tr_b16 v[60:61], v6 offset:46080
ds_read_b64_tr_b16 v[62:63], v6 offset:46336
ds_read_b128 v[216:219], v4 offset:16384
ds_read_b64_tr_b16 v[64:65], v6 offset:43008
ds_read_b64_tr_b16 v[66:67], v6 offset:43264
ds_read_b64_tr_b16 v[68:69], v6 offset:47104
ds_read_b64_tr_b16 v[70:71], v6 offset:47360
ds_read_b128 v[220:223], v5 offset:16384
ds_read_b64_tr_b16 v[72:73], v6 offset:44032
ds_read_b64_tr_b16 v[74:75], v6 offset:44288
ds_read_b64_tr_b16 v[76:77], v6 offset:48128
ds_read_b64_tr_b16 v[78:79], v6 offset:48384
s_waitcnt lgkmcnt(15)
v_mfma_f32_32x32x16_bf16 v[16:31], v[48:51], v[208:211], v[16:31]
v_mfma_f32_32x32x16_bf16 v[32:47], v[52:55], v[208:211], v[32:47]
s_waitcnt lgkmcnt(10)
v_mfma_f32_32x32x16_bf16 v[16:31], v[56:59], v[212:215], v[16:31]
v_mfma_f32_32x32x16_bf16 v[32:47], v[60:63], v[212:215], v[32:47]
s_waitcnt lgkmcnt(5)
v_mfma_f32_32x32x16_bf16 v[16:31], v[64:67], v[216:219], v[16:31]
v_mfma_f32_32x32x16_bf16 v[32:47], v[68:71], v[216:219], v[32:47]
s_waitcnt lgkmcnt(0)
v_mfma_f32_32x32x16_bf16 v[16:31], v[72:75], v[220:223], v[16:31]
v_mfma_f32_32x32x16_bf16 v[32:47], v[76:79], v[220:223], v[32:47]
s_barrier
ds_read_b128 v[224:227], v2 offset:32768
ds_read_b64_tr_b16 v[48:49], v6 offset:49152
ds_read_b64_tr_b16 v[50:51], v6 offset:49408
ds_read_b64_tr_b16 v[52:53], v6 offset:53248
ds_read_b64_tr_b16 v[54:55], v6 offset:53504
ds_read_b128 v[228:231], v3 offset:32768
ds_read_b64_tr_b16 v[56:57], v6 offset:50176
ds_read_b64_tr_b16 v[58:59], v6 offset:50432
ds_read_b64_tr_b16 v[60:61], v6 offset:54272
ds_read_b64_tr_b16 v[62:63], v6 offset:54528
ds_read_b128 v[232:235], v4 offset:32768
ds_read_b64_tr_b16 v[64:65], v6 offset:51200
ds_read_b64_tr_b16 v[66:67], v6 offset:51456
ds_read_b64_tr_b16 v[68:69], v6 offset:55296
ds_read_b64_tr_b16 v[70:71], v6 offset:55552
ds_read_b128 v[236:239], v5 offset:32768
ds_read_b64_tr_b16 v[72:73], v6 offset:52224
ds_read_b64_tr_b16 v[74:75], v6 offset:52480
ds_read_b64_tr_b16 v[76:77], v6 offset:56320
ds_read_b64_tr_b16 v[78:79], v6 offset:56576
ds_read_b32 v14, v10 offset:44
s_waitcnt lgkmcnt(15)
v_mfma_f32_32x32x16_bf16 v[16:31], v[48:51], v[224:227], v[16:31]
v_mfma_f32_32x32x16_bf16 v[32:47], v[52:55], v[224:227], v[32:47]
s_waitcnt lgkmcnt(11)
v_mfma_f32_32x32x16_bf16 v[16:31], v[56:59], v[228:231], v[16:31]
v_mfma_f32_32x32x16_bf16 v[32:47], v[60:63], v[228:231], v[32:47]
s_waitcnt lgkmcnt(6)
v_mfma_f32_32x32x16_bf16 v[16:31], v[64:67], v[232:235], v[16:31]
v_mfma_f32_32x32x16_bf16 v[32:47], v[68:71], v[232:235], v[32:47]
s_waitcnt lgkmcnt(1)
s_mov_b64 exec, 1
ds_add_u32 v10, v11 offset:32
s_mov_b64 exec, -1
v_mfma_f32_32x32x16_bf16 v[16:31], v[72:75], v[236:239], v[16:31]
v_mfma_f32_32x32x16_bf16 v[32:47], v[76:79], v[236:239], v[32:47]
s_waitcnt lgkmcnt(1)
s_mov_b32 s80, 0x9e3779b1
v_mul_lo_u32 v12, v14, s80
v_cmp_lt_u32 vcc, 1, v124
v_and_b32 v13, 1, v0
v_lshlrev_b32 v13, 4, v13
v_cndmask_b32 v12, v14, v12, vcc
v_xor_b32 v13, 16, v13
v_lshlrev_b32 v12, v13, v12
v_and_b32 v107, 0xbfff0000, v12
s_nop 0
v_cvt_pk_bf16_f32 v48, v16, v17
v_cvt_pk_bf16_f32 v49, v18, v19
v_cvt_pk_bf16_f32 v50, v20, v21
v_cvt_pk_bf16_f32 v51, v22, v23
v_cvt_pk_bf16_f32 v52, v24, v25
v_cvt_pk_bf16_f32 v53, v26, v27
v_cvt_pk_bf16_f32 v54, v28, v29
v_cvt_pk_bf16_f32 v55, v30, v31
v_mfma_f32_32x32x16_bf16 v[16:31], v[80:83], v[48:51], 0
s_nop 0
v_mfma_f32_32x32x16_bf16 v[16:31], v[84:87], v[52:55], v[16:31]
v_cvt_pk_bf16_f32 v56, v32, v33
v_cvt_pk_bf16_f32 v57, v34, v35
v_cvt_pk_bf16_f32 v58, v36, v37
v_cvt_pk_bf16_f32 v59, v38, v39
v_cvt_pk_bf16_f32 v60, v40, v41
v_cvt_pk_bf16_f32 v61, v42, v43
v_cvt_pk_bf16_f32 v62, v44, v45
v_cvt_pk_bf16_f32 v63, v46, v47
s_mov_b32 exec_lo, 0
v_mov_b32 v62, 0x3f80
v_mov_b32 v63, 0
s_mov_b32 exec_lo, -1
ds_write_b64 v112, v[56:57] offset:16384
ds_write_b64 v113, v[58:59] offset:16384
ds_write_b64 v114, v[60:61] offset:16384
ds_write_b64 v115, v[62:63] offset:16384
v_cvt_pk_bf16_f32 v64, v16, v17
v_cvt_pk_bf16_f32 v65, v18, v19
v_cvt_pk_bf16_f32 v66, v20, v21
v_cvt_pk_bf16_f32 v67, v22, v24
v_cvt_pk_bf16_f32 v68, v25, v26
v_cvt_pk_bf16_f32 v69, v27, v28
v_cvt_pk_bf16_f32 v70, v29, v30
v_lshlrev_b32 v16, 16, v64
v_and_b32 v17, s88, v64
v_lshlrev_b32 v18, 16, v65
v_and_b32 v19, s88, v65
v_lshlrev_b32 v20, 16, v66
v_and_b32 v21, s88, v66
v_lshlrev_b32 v22, 16, v67
v_and_b32 v24, s88, v67
v_lshlrev_b32 v25, 16, v68
v_and_b32 v26, s88, v68
v_lshlrev_b32 v27, 16, v69
v_and_b32 v28, s88, v69
v_lshlrev_b32 v29, 16, v70
v_and_b32 v30, s88, v70
v_max3_f32 v88, v16, v17, v18
v_min3_f32 v90, v16, v17, v18
v_max3_f32 v88, v88, v19, v20
v_min3_f32 v90, v90, v19, v20
v_max3_f32 v88, v88, v21, v22
v_min3_f32 v90, v90, v21, v22
v_max3_f32 v88, v88, v24, v25
v_min3_f32 v90, v90, v24, v25
v_max3_f32 v88, v88, v26, v27
v_min3_f32 v90, v90, v26, v27
v_max3_f32 v88, v88, v28, v29
v_min3_f32 v90, v90, v28, v29
v_max_f32 v88, v88, v30
v_min_f32 v90, v90, v30
v_mov_b32 v89, v88
v_mov_b32 v91, v90
s_nop 0
v_permlane32_swap_b32 v88, v89
v_permlane32_swap_b32 v90, v91
v_max_f32 v88, v88, v89
v_min_f32 v90, v90, v91
v_mul_f32 v88, s87, v88
v_mul_f32 v90, s86, v90
v_pk_fma_f32 v[64:65], v[16:17], s[86:87], v[88:89] op_sel_hi:[1,0,0]
v_pk_fma_f32 v[16:17], v[16:17], s[86:87], v[90:91] op_sel:[0,1,0] op_sel_hi:[1,1,0]
v_pk_fma_f32 v[66:67], v[18:19], s[86:87], v[88:89] op_sel_hi:[1,0,0]
v_pk_fma_f32 v[18:19], v[18:19], s[86:87], v[90:91] op_sel:[0,1,0] op_sel_hi:[1,1,0]
v_pk_fma_f32 v[68:69], v[20:21], s[86:87], v[88:89] op_sel_hi:[1,0,0]
v_pk_fma_f32 v[20:21], v[20:21], s[86:87], v[90:91] op_sel:[0,1,0] op_sel_hi:[1,1,0]
v_pk_fma_f32 v[72:73], v[24:25], s[86:87], v[88:89] op_sel_hi:[1,0,0]
v_pk_fma_f32 v[24:25], v[24:25], s[86:87], v[90:91] op_sel:[0,1,0] op_sel_hi:[1,1,0]
v_pk_fma_f32 v[74:75], v[26:27], s[86:87], v[88:89] op_sel_hi:[1,0,0]
v_pk_fma_f32 v[26:27], v[26:27], s[86:87], v[90:91] op_sel:[0,1,0] op_sel_hi:[1,1,0]
v_pk_fma_f32 v[76:77], v[28:29], s[86:87], v[88:89] op_sel_hi:[1,0,0]
v_pk_fma_f32 v[28:29], v[28:29], s[86:87], v[90:91] op_sel:[0,1,0] op_sel_hi:[1,1,0]
v_fma_f32 v70, v22, s86, v88
v_fma_f32 v22, v22, s87, v90
v_fma_f32 v78, v30, s86, v88
v_fma_f32 v30, v30, s87, v90
v_exp_f32 v64, v64
v_exp_f32 v16, v16
v_exp_f32 v65, v65
v_exp_f32 v17, v17
v_exp_f32 v66, v66
v_exp_f32 v18, v18
v_exp_f32 v67, v67
v_exp_f32 v19, v19
v_exp_f32 v68, v68
v_exp_f32 v20, v20
v_exp_f32 v69, v69
v_exp_f32 v21, v21
v_exp_f32 v70, v70
v_exp_f32 v22, v22
v_exp_f32 v72, v72
v_exp_f32 v24, v24
v_exp_f32 v73, v73
v_exp_f32 v25, v25
v_exp_f32 v74, v74
v_exp_f32 v26, v26
v_exp_f32 v75, v75
v_exp_f32 v27, v27
v_exp_f32 v76, v76
v_exp_f32 v28, v28
v_exp_f32 v77, v77
v_exp_f32 v29, v29
v_exp_f32 v78, v78
v_exp_f32 v30, v30
v_pk_add_f32 v[92:93], v[64:65], v[66:67]
v_pk_add_f32 v[94:95], v[16:17], v[18:19]
v_pk_add_f32 v[92:93], v[92:93], v[68:69]
v_pk_add_f32 v[94:95], v[94:95], v[20:21]
v_pk_add_f32 v[92:93], v[92:93], v[72:73]
v_pk_add_f32 v[94:95], v[94:95], v[24:25]
v_pk_add_f32 v[92:93], v[92:93], v[74:75]
v_pk_add_f32 v[94:95], v[94:95], v[26:27]
v_pk_add_f32 v[92:93], v[92:93], v[76:77]
v_pk_add_f32 v[94:95], v[94:95], v[28:29]
v_add_f32 v92, v92, v70
v_add_f32 v94, v94, v22
v_add_f32 v93, v93, v78
v_add_f32 v95, v95, v30
v_add_f32 v92, v92, v93
v_add_f32 v94, v94, v95
v_mov_b32 v89, v92
v_mov_b32 v91, v94
s_nop 0
v_permlane32_swap_b32 v92, v89
v_permlane32_swap_b32 v94, v91
v_add_f32 v92, v92, v89
v_add_f32 v94, v94, v91
v_rcp_f32 v92, v92
v_rcp_f32 v94, v94
v_pk_mul_f32 v[64:65], v[64:65], v[92:93] op_sel_hi:[1,0]
v_pk_mul_f32 v[16:17], v[16:17], v[94:95] op_sel_hi:[1,0]
v_pk_mul_f32 v[66:67], v[66:67], v[92:93] op_sel_hi:[1,0]
v_pk_mul_f32 v[18:19], v[18:19], v[94:95] op_sel_hi:[1,0]
v_pk_mul_f32 v[68:69], v[68:69], v[92:93] op_sel_hi:[1,0]
v_pk_mul_f32 v[20:21], v[20:21], v[94:95] op_sel_hi:[1,0]
v_pk_mul_f32 v[72:73], v[72:73], v[92:93] op_sel_hi:[1,0]
v_pk_mul_f32 v[24:25], v[24:25], v[94:95] op_sel_hi:[1,0]
v_pk_mul_f32 v[74:75], v[74:75], v[92:93] op_sel_hi:[1,0]
v_pk_mul_f32 v[26:27], v[26:27], v[94:95] op_sel_hi:[1,0]
v_pk_mul_f32 v[76:77], v[76:77], v[92:93] op_sel_hi:[1,0]
v_pk_mul_f32 v[28:29], v[28:29], v[94:95] op_sel_hi:[1,0]
v_mul_f32 v70, v70, v92
v_mul_f32 v22, v22, v94
v_mul_f32 v78, v78, v92
v_mul_f32 v30, v30, v94
v_cvt_pk_bf16_f32 v32, v64, v65
v_cvt_pk_bf16_f32 v40, v16, v17
v_cvt_pk_bf16_f32 v33, v66, v67
v_cvt_pk_bf16_f32 v41, v18, v19
v_cvt_pk_bf16_f32 v34, v68, v69
v_cvt_pk_bf16_f32 v42, v20, v21
v_cvt_pk_bf16_f32 v35, v70, 0
v_cvt_pk_bf16_f32 v43, v22, 0
v_cvt_pk_bf16_f32 v36, v72, v73
v_cvt_pk_bf16_f32 v44, v24, v25
v_cvt_pk_bf16_f32 v37, v74, v75
v_cvt_pk_bf16_f32 v45, v26, v27
v_cvt_pk_bf16_f32 v38, v76, v77
v_cvt_pk_bf16_f32 v46, v28, v29
v_cvt_pk_bf16_f32 v39, v78, 0
v_cvt_pk_bf16_f32 v47, v30, 0
ds_write_b64 v112, v[32:33]
ds_write_b64 v112, v[40:41] offset:2048
ds_write_b64 v113, v[34:35]
ds_write_b64 v113, v[42:43] offset:2048
ds_write_b64 v114, v[36:37]
ds_write_b64 v114, v[44:45] offset:2048
ds_write_b64 v115, v[38:39]
ds_write_b64 v115, v[46:47] offset:2048
s_waitcnt lgkmcnt(0)
s_mov_b64 exec, 1
ds_add_u32 v10, v11 offset:0
s_mov_b64 exec, -1
Lw_22:
ds_read_b32 v12, v10 offset:0
s_sub_u32 s78, s78, 1
s_cbranch_scc1 LEND
s_waitcnt lgkmcnt(0)
v_readfirstlane_b32 s80, v12
s_nop 0
s_cmp_ge_u32 s80, 4
s_cbranch_scc0 Lw_22
ds_read_b64_tr_b16 v[32:33], v116 offset:0
ds_read_b64_tr_b16 v[34:35], v117 offset:0
ds_read_b64_tr_b16 v[48:49], v118 offset:0
ds_read_b64_tr_b16 v[50:51], v119 offset:0
ds_read_b64_tr_b16 v[64:65], v120 offset:0
ds_read_b64_tr_b16 v[66:67], v121 offset:0
ds_read_b64_tr_b16 v[36:37], v116 offset:4096
ds_read_b64_tr_b16 v[38:39], v117 offset:4096
ds_read_b64_tr_b16 v[52:53], v118 offset:4096
ds_read_b64_tr_b16 v[54:55], v119 offset:4096
ds_read_b64_tr_b16 v[68:69], v120 offset:4096
ds_read_b64_tr_b16 v[70:71], v121 offset:4096
ds_read_b64_tr_b16 v[40:41], v116 offset:8192
ds_read_b64_tr_b16 v[42:43], v117 offset:8192
ds_read_b64_tr_b16 v[56:57], v118 offset:8192
ds_read_b64_tr_b16 v[58:59], v119 offset:8192
ds_read_b64_tr_b16 v[72:73], v120 offset:8192
ds_read_b64_tr_b16 v[74:75], v121 offset:8192
s_waitcnt lgkmcnt(12)
v_mfma_f32_16x16x32_bf16 v[16:19], v[32:35], v[48:51], 0
v_mfma_f32_16x16x32_bf16 v[20:23], v[32:35], v[64:67], 0
ds_read_b64_tr_b16 v[44:45], v116 offset:12288
ds_read_b64_tr_b16 v[46:47], v117 offset:12288
ds_read_b64_tr_b16 v[60:61], v118 offset:12288
ds_read_b64_tr_b16 v[62:63], v119 offset:12288
ds_read_b64_tr_b16 v[76:77], v120 offset:12288
ds_read_b64_tr_b16 v[78:79], v121 offset:12288
s_waitcnt lgkmcnt(12)
v_mfma_f32_16x16x32_bf16 v[16:19], v[36:39], v[52:55], v[16:19]
v_mfma_f32_16x16x32_bf16 v[20:23], v[36:39], v[68:71], v[20:23]
s_waitcnt lgkmcnt(6)
v_mfma_f32_16x16x32_bf16 v[16:19], v[40:43], v[56:59], v[16:19]
v_mfma_f32_16x16x32_bf16 v[20:23], v[40:43], v[72:75], v[20:23]
s_waitcnt lgkmcnt(0)
v_mfma_f32_16x16x32_bf16 v[16:19], v[44:47], v[60:63], v[16:19]
v_mfma_f32_16x16x32_bf16 v[20:23], v[44:47], v[76:79], v[20:23]
ds_read_b32 v13, v10 offset:16
v_add_u32 v88, 0, v6
s_nop 4
v_cvt_pk_bf16_f32 v24, v16, v17
v_cvt_pk_bf16_f32 v25, v18, v19
v_cvt_pk_bf16_f32 v26, v20, v21
v_cvt_pk_bf16_f32 v27, v22, v23
s_nop 0
v_permlane32_swap_b32 v24, v26
v_permlane32_swap_b32 v25, v27
v_bfi_b32 v27, s89, v27, v107
buffer_store_dwordx4 v[24:27], v125, s[48:51], s92 offen sc1
s_waitcnt lgkmcnt(0)
v_readfirstlane_b32 s80, v13
s_nop 0
s_cmp_ge_u32 s80, 4
s_cbranch_scc1 Lwq_23
Lw_24:
ds_read_b32 v13, v10 offset:16
s_sub_u32 s78, s78, 1
s_cbranch_scc1 LEND
s_waitcnt lgkmcnt(0)
v_readfirstlane_b32 s80, v13
s_nop 0
s_cmp_ge_u32 s80, 4
s_cbranch_scc0 Lw_24
Lwq_23:
ds_read_b64_tr_b16 v[48:49], v88 offset:0
ds_read_b64_tr_b16 v[50:51], v88 offset:256
ds_read_b64_tr_b16 v[52:53], v88 offset:1024
ds_read_b64_tr_b16 v[54:55], v88 offset:1280
ds_read_b64_tr_b16 v[56:57], v88 offset:2048
ds_read_b64_tr_b16 v[58:59], v88 offset:2304
ds_read_b64_tr_b16 v[60:61], v88 offset:3072
ds_read_b64_tr_b16 v[62:63], v88 offset:3328
ds_read_b64_tr_b16 v[64:65], v88 offset:4096
ds_read_b64_tr_b16 v[66:67], v88 offset:4352
ds_read_b64_tr_b16 v[68:69], v88 offset:5120
ds_read_b64_tr_b16 v[70:71], v88 offset:5376
s_waitcnt lgkmcnt(10)
v_mfma_f32_32x32x16_bf16 v[32:47], v[48:51], v[128:131], 0
ds_read_b64_tr_b16 v[72:73], v88 offset:6144
ds_read_b64_tr_b16 v[74:75], v88 offset:6400
s_waitcnt lgkmcnt(10)
v_mfma_f32_32x32x16_bf16 v[32:47], v[52:55], v[132:135], v[32:47]
ds_read_b64_tr_b16 v[76:77], v88 offset:7168
ds_read_b64_tr_b16 v[78:79], v88 offset:7424
s_waitcnt lgkmcnt(10)
v_mfma_f32_32x32x16_bf16 v[32:47], v[56:59], v[136:139], v[32:47]
ds_read_b64_tr_b16 v[48:49], v88 offset:8192
ds_read_b64_tr_b16 v[50:51], v88 offset:8448
s_waitcnt lgkmcnt(10)
v_mfma_f32_32x32x16_bf16 v[32:47], v[60:63], v[140:143], v[32:47]
ds_read_b64_tr_b16 v[52:53], v88 offset:9216
ds_read_b64_tr_b16 v[54:55], v88 offset:9472
s_waitcnt lgkmcnt(10)
v_mfma_f32_32x32x16_bf16 v[32:47], v[64:67], v[144:147], v[32:47]
ds_read_b64_tr_b16 v[56:57], v88 offset:10240
ds_read_b64_tr_b16 v[58:59], v88 offset:10496
s_waitcnt lgkmcnt(10)
v_mfma_f32_32x32x16_bf16 v[32:47], v[68:71], v[148:151], v[32:47]
ds_read_b64_tr_b16 v[60:61], v88 offset:11264
ds_read_b64_tr_b16 v[62:63], v88 offset:11520
s_waitcnt lgkmcnt(10)
v_mfma_f32_32x32x16_bf16 v[32:47], v[72:75], v[152:155], v[32:47]
ds_read_b64_tr_b16 v[64:65], v88 offset:12288
ds_read_b64_tr_b16 v[66:67], v88 offset:12544
s_waitcnt lgkmcnt(10)
v_mfma_f32_32x32x16_bf16 v[32:47], v[76:79], v[156:159], v[32:47]
ds_read_b64_tr_b16 v[68:69], v88 offset:13312
ds_read_b64_tr_b16 v[70:71], v88 offset:13568
s_waitcnt lgkmcnt(10)
v_mfma_f32_32x32x16_bf16 v[32:47], v[48:51], v[160:163], v[32:47]
ds_read_b64_tr_b16 v[72:73], v88 offset:14336
ds_read_b64_tr_b16 v[74:75], v88 offset:14592
s_waitcnt lgkmcnt(10)
v_mfma_f32_32x32x16_bf16 v[32:47], v[52:55], v[164:167], v[32:47]
ds_read_b64_tr_b16 v[76:77], v88 offset:15360
ds_read_b64_tr_b16 v[78:79], v88 offset:15616
s_waitcnt lgkmcnt(10)
v_mfma_f32_32x32x16_bf16 v[32:47], v[56:59], v[168:171], v[32:47]
ds_read_b64_tr_b16 v[48:49], v88 offset:16384
ds_read_b64_tr_b16 v[50:51], v88 offset:16640
s_waitcnt lgkmcnt(10)
v_mfma_f32_32x32x16_bf16 v[32:47], v[60:63], v[172:175], v[32:47]
ds_read_b64_tr_b16 v[52:53], v88 offset:17408
ds_read_b64_tr_b16 v[54:55], v88 offset:17664
s_waitcnt lgkmcnt(10)
v_mfma_f32_32x32x16_bf16 v[32:47], v[64:67], v[176:179], v[32:47]
ds_read_b64_tr_b16 v[56:57], v88 offset:18432
ds_read_b64_tr_b16 v[58:59], v88 offset:18688
s_waitcnt lgkmcnt(10)
v_mfma_f32_32x32x16_bf16 v[32:47], v[68:71], v[180:183], v[32:47]
ds_read_b64_tr_b16 v[60:61], v88 offset:19456
ds_read_b64_tr_b16 v[62:63], v88 offset:19712
s_waitcnt lgkmcnt(10)
v_mfma_f32_32x32x16_bf16 v[32:47], v[72:75], v[184:187], v[32:47]
ds_read_b64_tr_b16 v[64:65], v88 offset:20480
ds_read_b64_tr_b16 v[66:67], v88 offset:20736
s_waitcnt lgkmcnt(10)
v_mfma_f32_32x32x16_bf16 v[32:47], v[76:79], v[188:191], v[32:47]
ds_read_b64_tr_b16 v[68:69], v88 offset:21504
ds_read_b64_tr_b16 v[70:71], v88 offset:21760
s_waitcnt lgkmcnt(10)
v_mfma_f32_32x32x16_bf16 v[32:47], v[48:51], v[192:195], v[32:47]
ds_read_b64_tr_b16 v[72:73], v88 offset:22528
ds_read_b64_tr_b16 v[74:75], v88 offset:22784
s_waitcnt lgkmcnt(10)
v_mfma_f32_32x32x16_bf16 v[32:47], v[52:55], v[196:199], v[32:47]
ds_read_b64_tr_b16 v[76:77], v88 offset:23552
ds_read_b64_tr_b16 v[78:79], v88 offset:23808
s_waitcnt lgkmcnt(10)
v_mfma_f32_32x32x16_bf16 v[32:47], v[56:59], v[200:203], v[32:47]
ds_read_b64_tr_b16 v[48:49], v88 offset:24576
ds_read_b64_tr_b16 v[50:51], v88 offset:24832
s_waitcnt lgkmcnt(10)
v_mfma_f32_32x32x16_bf16 v[32:47], v[60:63], v[204:207], v[32:47]
ds_read_b64_tr_b16 v[52:53], v88 offset:25600
ds_read_b64_tr_b16 v[54:55], v88 offset:25856
s_waitcnt lgkmcnt(10)
v_mfma_f32_32x32x16_bf16 v[32:47], v[64:67], v[208:211], v[32:47]
ds_read_b64_tr_b16 v[56:57], v88 offset:26624
ds_read_b64_tr_b16 v[58:59], v88 offset:26880
s_waitcnt lgkmcnt(10)
v_mfma_f32_32x32x16_bf16 v[32:47], v[68:71], v[212:215], v[32:47]
ds_read_b64_tr_b16 v[60:61], v88 offset:27648
ds_read_b64_tr_b16 v[62:63], v88 offset:27904
s_waitcnt lgkmcnt(10)
v_mfma_f32_32x32x16_bf16 v[32:47], v[72:75], v[216:219], v[32:47]
s_waitcnt lgkmcnt(8)
v_mfma_f32_32x32x16_bf16 v[32:47], v[76:79], v[220:223], v[32:47]
s_waitcnt lgkmcnt(6)
v_mfma_f32_32x32x16_bf16 v[32:47], v[48:51], v[224:227], v[32:47]
s_waitcnt lgkmcnt(4)
v_mfma_f32_32x32x16_bf16 v[32:47], v[52:55], v[228:231], v[32:47]
s_waitcnt lgkmcnt(2)
v_mfma_f32_32x32x16_bf16 v[32:47], v[56:59], v[232:235], v[32:47]
s_waitcnt lgkmcnt(0)
v_mfma_f32_32x32x16_bf16 v[32:47], v[60:63], v[236:239], v[32:47]
s_mov_b64 exec, 1
ds_add_u32 v10, v11 offset:68
s_mov_b64 exec, -1
s_nop 8
v_cvt_pk_bf16_f32 v48, v32, v33
v_cvt_pk_bf16_f32 v49, v34, v35
v_cvt_pk_bf16_f32 v50, v36, v37
v_cvt_pk_bf16_f32 v51, v38, v39
v_cvt_pk_bf16_f32 v52, v40, v41
v_cvt_pk_bf16_f32 v53, v42, v43
v_cvt_pk_bf16_f32 v54, v44, v45
v_cvt_pk_bf16_f32 v55, v46, v47
v_mfma_f32_32x32x16_bf16 v[16:31], v[80:83], v[48:51], 0
s_nop 0
v_mfma_f32_32x32x16_bf16 v[16:31], v[84:87], v[52:55], v[16:31]
s_nop 11
v_cvt_pk_bf16_f32 v64, v16, v17
v_cvt_pk_bf16_f32 v65, v18, v19
v_cvt_pk_bf16_f32 v66, v20, v21
v_cvt_pk_bf16_f32 v67, v22, v24
v_cvt_pk_bf16_f32 v68, v25, v26
v_cvt_pk_bf16_f32 v69, v27, v28
v_cvt_pk_bf16_f32 v70, v29, v30
v_lshlrev_b32 v16, 16, v64
v_and_b32 v17, s88, v64
v_lshlrev_b32 v18, 16, v65
v_and_b32 v19, s88, v65
v_lshlrev_b32 v20, 16, v66
v_and_b32 v21, s88, v66
v_lshlrev_b32 v22, 16, v67
v_and_b32 v24, s88, v67
v_lshlrev_b32 v25, 16, v68
v_and_b32 v26, s88, v68
v_lshlrev_b32 v27, 16, v69
v_and_b32 v28, s88, v69
v_lshlrev_b32 v29, 16, v70
v_and_b32 v30, s88, v70
v_max3_f32 v88, v16, v17, v18
v_min3_f32 v90, v16, v17, v18
v_max3_f32 v88, v88, v19, v20
v_min3_f32 v90, v90, v19, v20
v_max3_f32 v88, v88, v21, v22
v_min3_f32 v90, v90, v21, v22
v_max3_f32 v88, v88, v24, v25
v_min3_f32 v90, v90, v24, v25
v_max3_f32 v88, v88, v26, v27
v_min3_f32 v90, v90, v26, v27
v_max3_f32 v88, v88, v28, v29
v_min3_f32 v90, v90, v28, v29
v_max_f32 v88, v88, v30
v_min_f32 v90, v90, v30
v_mov_b32 v89, v88
v_mov_b32 v91, v90
s_nop 0
v_permlane32_swap_b32 v88, v89
v_permlane32_swap_b32 v90, v91
v_max_f32 v88, v88, v89
v_min_f32 v90, v90, v91
v_mul_f32 v88, s87, v88
v_mul_f32 v90, s86, v90
v_pk_fma_f32 v[64:65], v[16:17], s[86:87], v[88:89] op_sel_hi:[1,0,0]
v_pk_fma_f32 v[16:17], v[16:17], s[86:87], v[90:91] op_sel:[0,1,0] op_sel_hi:[1,1,0]
v_pk_fma_f32 v[66:67], v[18:19], s[86:87], v[88:89] op_sel_hi:[1,0,0]
v_pk_fma_f32 v[18:19], v[18:19], s[86:87], v[90:91] op_sel:[0,1,0] op_sel_hi:[1,1,0]
v_pk_fma_f32 v[68:69], v[20:21], s[86:87], v[88:89] op_sel_hi:[1,0,0]
v_pk_fma_f32 v[20:21], v[20:21], s[86:87], v[90:91] op_sel:[0,1,0] op_sel_hi:[1,1,0]
v_pk_fma_f32 v[72:73], v[24:25], s[86:87], v[88:89] op_sel_hi:[1,0,0]
v_pk_fma_f32 v[24:25], v[24:25], s[86:87], v[90:91] op_sel:[0,1,0] op_sel_hi:[1,1,0]
v_pk_fma_f32 v[74:75], v[26:27], s[86:87], v[88:89] op_sel_hi:[1,0,0]
v_pk_fma_f32 v[26:27], v[26:27], s[86:87], v[90:91] op_sel:[0,1,0] op_sel_hi:[1,1,0]
v_pk_fma_f32 v[76:77], v[28:29], s[86:87], v[88:89] op_sel_hi:[1,0,0]
v_pk_fma_f32 v[28:29], v[28:29], s[86:87], v[90:91] op_sel:[0,1,0] op_sel_hi:[1,1,0]
v_fma_f32 v70, v22, s86, v88
v_fma_f32 v22, v22, s87, v90
v_fma_f32 v78, v30, s86, v88
v_fma_f32 v30, v30, s87, v90
v_exp_f32 v64, v64
v_exp_f32 v16, v16
v_exp_f32 v65, v65
v_exp_f32 v17, v17
v_exp_f32 v66, v66
v_exp_f32 v18, v18
v_exp_f32 v67, v67
v_exp_f32 v19, v19
v_exp_f32 v68, v68
v_exp_f32 v20, v20
v_exp_f32 v69, v69
v_exp_f32 v21, v21
v_exp_f32 v70, v70
v_exp_f32 v22, v22
v_exp_f32 v72, v72
v_exp_f32 v24, v24
v_exp_f32 v73, v73
v_exp_f32 v25, v25
v_exp_f32 v74, v74
v_exp_f32 v26, v26
v_exp_f32 v75, v75
v_exp_f32 v27, v27
v_exp_f32 v76, v76
v_exp_f32 v28, v28
v_exp_f32 v77, v77
v_exp_f32 v29, v29
v_exp_f32 v78, v78
v_exp_f32 v30, v30
v_pk_add_f32 v[92:93], v[64:65], v[66:67]
v_pk_add_f32 v[94:95], v[16:17], v[18:19]
v_pk_add_f32 v[92:93], v[92:93], v[68:69]
v_pk_add_f32 v[94:95], v[94:95], v[20:21]
v_pk_add_f32 v[92:93], v[92:93], v[72:73]
v_pk_add_f32 v[94:95], v[94:95], v[24:25]
v_pk_add_f32 v[92:93], v[92:93], v[74:75]
v_pk_add_f32 v[94:95], v[94:95], v[26:27]
v_pk_add_f32 v[92:93], v[92:93], v[76:77]
v_pk_add_f32 v[94:95], v[94:95], v[28:29]
v_add_f32 v92, v92, v70
v_add_f32 v94, v94, v22
v_add_f32 v93, v93, v78
v_add_f32 v95, v95, v30
v_add_f32 v92, v92, v93
v_add_f32 v94, v94, v95
v_mov_b32 v89, v92
v_mov_b32 v91, v94
s_nop 0
v_permlane32_swap_b32 v92, v89
v_permlane32_swap_b32 v94, v91
v_add_f32 v92, v92, v89
v_add_f32 v94, v94, v91
v_rcp_f32 v92, v92
v_rcp_f32 v94, v94
v_pk_mul_f32 v[64:65], v[64:65], v[92:93] op_sel_hi:[1,0]
v_pk_mul_f32 v[16:17], v[16:17], v[94:95] op_sel_hi:[1,0]
v_pk_mul_f32 v[66:67], v[66:67], v[92:93] op_sel_hi:[1,0]
v_pk_mul_f32 v[18:19], v[18:19], v[94:95] op_sel_hi:[1,0]
v_pk_mul_f32 v[68:69], v[68:69], v[92:93] op_sel_hi:[1,0]
v_pk_mul_f32 v[20:21], v[20:21], v[94:95] op_sel_hi:[1,0]
v_pk_mul_f32 v[72:73], v[72:73], v[92:93] op_sel_hi:[1,0]
v_pk_mul_f32 v[24:25], v[24:25], v[94:95] op_sel_hi:[1,0]
v_pk_mul_f32 v[74:75], v[74:75], v[92:93] op_sel_hi:[1,0]
v_pk_mul_f32 v[26:27], v[26:27], v[94:95] op_sel_hi:[1,0]
v_pk_mul_f32 v[76:77], v[76:77], v[92:93] op_sel_hi:[1,0]
v_pk_mul_f32 v[28:29], v[28:29], v[94:95] op_sel_hi:[1,0]
v_mul_f32 v70, v70, v92
v_mul_f32 v22, v22, v94
v_mul_f32 v78, v78, v92
v_mul_f32 v30, v30, v94
v_cvt_pk_bf16_f32 v112, v64, v65
v_cvt_pk_bf16_f32 v80, v16, v17
v_cvt_pk_bf16_f32 v113, v66, v67
v_cvt_pk_bf16_f32 v81, v18, v19
v_cvt_pk_bf16_f32 v114, v68, v69
v_cvt_pk_bf16_f32 v82, v20, v21
v_cvt_pk_bf16_f32 v115, v70, 0
v_cvt_pk_bf16_f32 v83, v22, 0
v_cvt_pk_bf16_f32 v116, v72, v73
v_cvt_pk_bf16_f32 v84, v24, v25
v_cvt_pk_bf16_f32 v117, v74, v75
v_cvt_pk_bf16_f32 v85, v26, v27
v_cvt_pk_bf16_f32 v118, v76, v77
v_cvt_pk_bf16_f32 v86, v28, v29
v_cvt_pk_bf16_f32 v119, v78, 0
v_cvt_pk_bf16_f32 v87, v30, 0
Lw_25:
ds_read_b32 v12, v10 offset:4
s_sub_u32 s78, s78, 1
s_cbranch_scc1 LEND
s_waitcnt lgkmcnt(0)
v_readfirstlane_b32 s80, v12
s_nop 0
s_cmp_ge_u32 s80, 4
s_cbranch_scc0 Lw_25
ds_read_b128 v[48:51], v105 offset:0
ds_read_b128 v[52:55], v105 offset:1024
ds_read_b128 v[56:59], v105 offset:2048
ds_read_b128 v[60:63], v105 offset:3072
s_waitcnt lgkmcnt(3)
v_mfma_f32_32x32x16_bf16 v[16:31], v[48:51], v[112:115], 0
s_waitcnt lgkmcnt(2)
v_mfma_f32_32x32x16_bf16 v[16:31], v[52:55], v[116:119], v[16:31]
s_waitcnt lgkmcnt(1)
v_mfma_f32_32x32x16_bf16 v[16:31], v[56:59], v[80:83], v[16:31]
s_waitcnt lgkmcnt(0)
v_mfma_f32_32x32x16_bf16 v[16:31], v[60:63], v[84:87], v[16:31]
ds_read_b32 v13, v10 offset:20
s_nop 10
v_add_f32 v88, 0x358637bd, v23
v_rcp_f32 v88, v88
s_nop 0
v_pk_mul_f32 v[16:17], v[16:17], v[88:89] op_sel_hi:[1,0]
v_pk_mul_f32 v[18:19], v[18:19], v[88:89] op_sel_hi:[1,0]
v_pk_mul_f32 v[20:21], v[20:21], v[88:89] op_sel_hi:[1,0]
v_pk_mul_f32 v[24:25], v[24:25], v[88:89] op_sel_hi:[1,0]
v_pk_mul_f32 v[26:27], v[26:27], v[88:89] op_sel_hi:[1,0]
v_pk_mul_f32 v[28:29], v[28:29], v[88:89] op_sel_hi:[1,0]
v_mul_f32 v22, v22, v88
v_mul_f32 v30, v30, v88
v_cvt_pk_bf16_f32 v32, v16, v17
v_cvt_pk_bf16_f32 v33, v18, v19
v_cvt_pk_bf16_f32 v34, v20, v21
v_cvt_pk_bf16_f32 v35, v22, 0
v_or_b32 v35, v35, v107
buffer_store_dwordx4 v[32:35], v9, s[48:51], s94 offen offset:0 sc1
v_cvt_pk_bf16_f32 v36, v24, v25
v_cvt_pk_bf16_f32 v37, v26, v27
v_cvt_pk_bf16_f32 v38, v28, v29
v_cvt_pk_bf16_f32 v39, v30, 0
v_or_b32 v39, v39, v107
buffer_store_dwordx4 v[36:39], v9, s[48:51], s94 offen offset:1024 sc1
s_cmp_lg_u32 s3, 7
s_cbranch_scc1 Lidle_26
s_sleep 42
s_mov_b64 exec, 1
ds_add_u32 v10, v11 offset:56
s_mov_b64 exec, -1
s_mov_b64 exec, 1
ds_add_u32 v10, v11 offset:12
s_mov_b64 exec, -1
s_mov_b64 exec, 1
ds_add_u32 v10, v11 offset:8
s_mov_b64 exec, -1
s_branch LBX
Lidle_26:
s_waitcnt lgkmcnt(0)
v_readfirstlane_b32 s80, v13
s_nop 0
s_cmp_ge_u32 s80, 4
s_cbranch_scc1 Lwo_27
Lw_28:
ds_read_b32 v12, v10 offset:20
s_sub_u32 s78, s78, 1
s_cbranch_scc1 LEND
s_waitcnt lgkmcnt(0)
v_readfirstlane_b32 s80, v12
s_nop 0
s_cmp_ge_u32 s80, 4
s_cbranch_scc0 Lw_28
Lwo_27:
ds_read_b64_tr_b16 v[128:129], v100 offset:0
ds_read_b64_tr_b16 v[130:131], v101 offset:0
ds_read_b64_tr_b16 v[132:133], v102 offset:0
ds_read_b64_tr_b16 v[134:135], v103 offset:0
ds_read_b64_tr_b16 v[136:137], v100 offset:3584
ds_read_b64_tr_b16 v[138:139], v101 offset:3584
ds_read_b64_tr_b16 v[140:141], v102 offset:3584
ds_read_b64_tr_b16 v[142:143], v103 offset:3584
ds_read_b64_tr_b16 v[144:145], v100 offset:7168
ds_read_b64_tr_b16 v[146:147], v101 offset:7168
ds_read_b64_tr_b16 v[148:149], v102 offset:7168
ds_read_b64_tr_b16 v[150:151], v103 offset:7168
ds_read_b64_tr_b16 v[152:153], v100 offset:10752
ds_read_b64_tr_b16 v[154:155], v101 offset:10752
ds_read_b64_tr_b16 v[156:157], v102 offset:10752
ds_read_b64_tr_b16 v[158:159], v103 offset:10752
ds_read_b64_tr_b16 v[160:161], v100 offset:14336
ds_read_b64_tr_b16 v[162:163], v101 offset:14336
ds_read_b64_tr_b16 v[164:165], v102 offset:14336
ds_read_b64_tr_b16 v[166:167], v103 offset:14336
ds_read_b64_tr_b16 v[168:169], v100 offset:17920
ds_read_b64_tr_b16 v[170:171], v101 offset:17920
ds_read_b64_tr_b16 v[172:173], v102 offset:17920
ds_read_b64_tr_b16 v[174:175], v103 offset:17920
ds_read_b64_tr_b16 v[176:177], v100 offset:21504
ds_read_b64_tr_b16 v[178:179], v101 offset:21504
ds_read_b64_tr_b16 v[180:181], v102 offset:21504
ds_read_b64_tr_b16 v[182:183], v103 offset:21504
ds_read_b64_tr_b16 v[184:185], v100 offset:25088
ds_read_b64_tr_b16 v[186:187], v101 offset:25088
ds_read_b64_tr_b16 v[188:189], v102 offset:25088
ds_read_b64_tr_b16 v[190:191], v103 offset:25088
v_add_u32 v100, 61440, v100
v_add_u32 v101, 61440, v101
v_add_u32 v102, 61440, v102
v_add_u32 v103, 61440, v103
ds_read_b64_tr_b16 v[192:193], v100 offset:0
ds_read_b64_tr_b16 v[194:195], v101 offset:0
ds_read_b64_tr_b16 v[196:197], v102 offset:0
ds_read_b64_tr_b16 v[198:199], v103 offset:0
ds_read_b64_tr_b16 v[200:201], v100 offset:3584
ds_read_b64_tr_b16 v[202:203], v101 offset:3584
ds_read_b64_tr_b16 v[204:205], v102 offset:3584
ds_read_b64_tr_b16 v[206:207], v103 offset:3584
ds_read_b64_tr_b16 v[208:209], v100 offset:7168
ds_read_b64_tr_b16 v[210:211], v101 offset:7168
ds_read_b64_tr_b16 v[212:213], v102 offset:7168
ds_read_b64_tr_b16 v[214:215], v103 offset:7168
ds_read_b64_tr_b16 v[216:217], v100 offset:10752
ds_read_b64_tr_b16 v[218:219], v101 offset:10752
ds_read_b64_tr_b16 v[220:221], v102 offset:10752
ds_read_b64_tr_b16 v[222:223], v103 offset:10752
ds_read_b64_tr_b16 v[224:225], v100 offset:14336
ds_read_b64_tr_b16 v[226:227], v101 offset:14336
ds_read_b64_tr_b16 v[228:229], v102 offset:14336
ds_read_b64_tr_b16 v[230:231], v103 offset:14336
ds_read_b64_tr_b16 v[232:233], v100 offset:17920
ds_read_b64_tr_b16 v[234:235], v101 offset:17920
ds_read_b64_tr_b16 v[236:237], v102 offset:17920
ds_read_b64_tr_b16 v[238:239], v103 offset:17920
ds_read_b64_tr_b16 v[240:241], v100 offset:21504
ds_read_b64_tr_b16 v[242:243], v101 offset:21504
ds_read_b64_tr_b16 v[244:245], v102 offset:21504
ds_read_b64_tr_b16 v[246:247], v103 offset:21504
ds_read_b64_tr_b16 v[248:249], v100 offset:25088
ds_read_b64_tr_b16 v[250:251], v101 offset:25088
ds_read_b64_tr_b16 v[252:253], v102 offset:25088
ds_read_b64_tr_b16 v[254:255], v103 offset:25088
v_mul_u32_u24 v88, 1792, v7
v_lshl_add_u32 v88, v8, 4, v88
s_cmp_lt_u32 s76, 2
s_cselect_b32 s81, 57344, 0
s_cselect_b32 s82, 0, 90112
v_add_u32 v91, s81, v9
v_add_u32 v92, s82, v91
s_and_b32 s80, s76, 1
s_lshl_b32 s81, s80, 14
s_mul_i32 s82, s82, s80
v_add_u32 v89, s81, v91
v_add_u32 v90, s82, v89
s_waitcnt lgkmcnt(0)
s_mov_b64 exec, 1
ds_add_u32 v10, v11 offset:12
s_mov_b64 exec, -1
s_lshr_b32 s80, 0xaa54, s74
s_bitcmp1_b32 s80, 0
s_cbranch_scc1 Lbo_29
Lbo_29:
s_bitcmp1_b32 s76, 0
s_cbranch_scc1 Lh2_30o
s_lshr_b32 s80, 0xaa54, s74
s_bitcmp1_b32 s80, 0
s_cbranch_scc1 Lbo_31
Lbo_31:
s_sleep 12
s_add_u32 s84, s95, 0
buffer_load_dwordx4 v[16:19], v9, s[48:51], s84 offen offset:0 sc1
buffer_load_dwordx4 v[20:23], v9, s[48:51], s84 offen offset:1024 sc1
s_add_u32 s84, s95, 0
buffer_load_dwordx4 v[24:27], v9, s[48:51], s84 offen offset:2048 sc1
buffer_load_dwordx4 v[28:31], v9, s[48:51], s84 offen offset:3072 sc1
s_add_u32 s84, s95, 4096
buffer_load_dwordx4 v[32:35], v9, s[48:51], s84 offen offset:0 sc1
buffer_load_dwordx4 v[36:39], v9, s[48:51], s84 offen offset:1024 sc1
s_add_u32 s84, s95, 4096
buffer_load_dwordx4 v[40:43], v9, s[48:51], s84 offen offset:2048 sc1
buffer_load_dwordx4 v[44:47], v9, s[48:51], s84 offen offset:3072 sc1
s_add_u32 s84, s95, 8192
buffer_load_dwordx4 v[48:51], v9, s[48:51], s84 offen offset:0 sc1
buffer_load_dwordx4 v[52:55], v9, s[48:51], s84 offen offset:1024 sc1
s_add_u32 s84, s95, 8192
buffer_load_dwordx4 v[56:59], v9, s[48:51], s84 offen offset:2048 sc1
buffer_load_dwordx4 v[60:63], v9, s[48:51], s84 offen offset:3072 sc1
s_add_u32 s84, s95, 12288
buffer_load_dwordx4 v[64:67], v9, s[48:51], s84 offen offset:0 sc1
buffer_load_dwordx4 v[68:71], v9, s[48:51], s84 offen offset:1024 sc1
s_add_u32 s84, s95, 12288
buffer_load_dwordx4 v[72:75], v9, s[48:51], s84 offen offset:2048 sc1
buffer_load_dwordx4 v[76:79], v9, s[48:51], s84 offen offset:3072 sc1
s_mov_b64 exec, 1
ds_add_u32 v10, v11 offset:56
s_mov_b64 exec, -1
s_waitcnt vmcnt(14)
v_bitop3_b32 v109, v19, v23, v107 bitop3:0x7e
v_xor_b32 v19, v107, v19
ds_write_b128 v89, v[16:19] offset:0
v_xor_b32 v23, v107, v23
ds_write_b128 v89, v[20:23] offset:1024
s_waitcnt vmcnt(12)
v_bitop3_b32 v109, v109, v27, v107 bitop3:0xf6
v_bitop3_b32 v109, v109, v31, v107 bitop3:0xf6
v_xor_b32 v27, v107, v27
ds_write_b128 v89, v[24:27] offset:2048
v_xor_b32 v31, v107, v31
ds_write_b128 v89, v[28:31] offset:3072
s_waitcnt vmcnt(10)
v_bitop3_b32 v109, v109, v35, v107 bitop3:0xf6
v_bitop3_b32 v109, v109, v39, v107 bitop3:0xf6
v_xor_b32 v35, v107, v35
ds_write_b128 v89, v[32:35] offset:4096
v_xor_b32 v39, v107, v39
ds_write_b128 v89, v[36:39] offset:5120
s_waitcnt vmcnt(8)
v_bitop3_b32 v109, v109, v43, v107 bitop3:0xf6
v_bitop3_b32 v109, v109, v47, v107 bitop3:0xf6
v_xor_b32 v43, v107, v43
ds_write_b128 v89, v[40:43] offset:6144
v_xor_b32 v47, v107, v47
ds_write_b128 v89, v[44:47] offset:7168
s_waitcnt vmcnt(6)
v_bitop3_b32 v109, v109, v51, v107 bitop3:0xf6
v_bitop3_b32 v109, v109, v55, v107 bitop3:0xf6
v_xor_b32 v51, v107, v51
ds_write_b128 v89, v[48:51] offset:8192
v_xor_b32 v55, v107, v55
ds_write_b128 v89, v[52:55] offset:9216
s_waitcnt vmcnt(4)
v_bitop3_b32 v109, v109, v59, v107 bitop3:0xf6
v_bitop3_b32 v109, v109, v63, v107 bitop3:0xf6
v_xor_b32 v59, v107, v59
ds_write_b128 v89, v[56:59] offset:10240
v_xor_b32 v63, v107, v63
ds_write_b128 v89, v[60:63] offset:11264
s_waitcnt vmcnt(2)
v_bitop3_b32 v109, v109, v67, v107 bitop3:0xf6
v_bitop3_b32 v109, v109, v71, v107 bitop3:0xf6
v_xor_b32 v67, v107, v67
ds_write_b128 v90, v[64:67] offset:12288
v_xor_b32 v71, v107, v71
ds_write_b128 v90, v[68:71] offset:13312
s_waitcnt vmcnt(0)
v_bitop3_b32 v109, v109, v75, v107 bitop3:0xf6
v_bitop3_b32 v109, v109, v79, v107 bitop3:0xf6
v_xor_b32 v75, v107, v75
ds_write_b128 v90, v[72:75] offset:14336
v_xor_b32 v79, v107, v79
ds_write_b128 v90, v[76:79] offset:15360
s_branch Lh2_30j
Lh2_30o:
s_lshr_b32 s80, 0xaa54, s74
s_bitcmp1_b32 s80, 0
s_cbranch_scc1 Lbo_32
Lbo_32:
s_sleep 12
s_add_u32 s84, s95, 0
buffer_load_dwordx4 v[16:19], v9, s[48:51], s84 offen offset:0 sc1
buffer_load_dwordx4 v[20:23], v9, s[48:51], s84 offen offset:1024 sc1
s_add_u32 s84, s95, 0
buffer_load_dwordx4 v[24:27], v9, s[48:51], s84 offen offset:2048 sc1
buffer_load_dwordx4 v[28:31], v9, s[48:51], s84 offen offset:3072 sc1
s_add_u32 s84, s95, 4096
buffer_load_dwordx4 v[32:35], v9, s[48:51], s84 offen offset:0 sc1
buffer_load_dwordx4 v[36:39], v9, s[48:51], s84 offen offset:1024 sc1
s_add_u32 s84, s95, 4096
buffer_load_dwordx4 v[40:43], v9, s[48:51], s84 offen offset:2048 sc1
buffer_load_dwordx4 v[44:47], v9, s[48:51], s84 offen offset:3072 sc1
s_add_u32 s84, s95, 8192
buffer_load_dwordx4 v[48:51], v9, s[48:51], s84 offen offset:0 sc1
buffer_load_dwordx4 v[52:55], v9, s[48:51], s84 offen offset:1024 sc1
s_add_u32 s84, s95, 8192
buffer_load_dwordx4 v[56:59], v9, s[48:51], s84 offen offset:2048 sc1
buffer_load_dwordx4 v[60:63], v9, s[48:51], s84 offen offset:3072 sc1
s_add_u32 s84, s95, 12288
buffer_load_dwordx4 v[64:67], v9, s[48:51], s84 offen offset:0 sc1
buffer_load_dwordx4 v[68:71], v9, s[48:51], s84 offen offset:1024 sc1
s_add_u32 s84, s95, 12288
buffer_load_dwordx4 v[72:75], v9, s[48:51], s84 offen offset:2048 sc1
buffer_load_dwordx4 v[76:79], v9, s[48:51], s84 offen offset:3072 sc1
s_mov_b64 exec, 1
ds_add_u32 v10, v11 offset:56
s_mov_b64 exec, -1
s_waitcnt vmcnt(14)
v_bitop3_b32 v109, v19, v23, v107 bitop3:0x7e
v_xor_b32 v19, v107, v19
ds_write_b128 v89, v[16:19] offset:0
v_xor_b32 v23, v107, v23
ds_write_b128 v89, v[20:23] offset:1024
s_waitcnt vmcnt(12)
v_bitop3_b32 v109, v109, v27, v107 bitop3:0xf6
v_bitop3_b32 v109, v109, v31, v107 bitop3:0xf6
v_xor_b32 v27, v107, v27
ds_write_b128 v89, v[24:27] offset:2048
v_xor_b32 v31, v107, v31
ds_write_b128 v89, v[28:31] offset:3072
s_waitcnt vmcnt(10)
v_bitop3_b32 v109, v109, v35, v107 bitop3:0xf6
v_bitop3_b32 v109, v109, v39, v107 bitop3:0xf6
v_xor_b32 v35, v107, v35
ds_write_b128 v89, v[32:35] offset:4096
v_xor_b32 v39, v107, v39
ds_write_b128 v89, v[36:39] offset:5120
s_waitcnt vmcnt(8)
v_bitop3_b32 v109, v109, v43, v107 bitop3:0xf6
v_bitop3_b32 v109, v109, v47, v107 bitop3:0xf6
v_xor_b32 v43, v107, v43
ds_write_b128 v89, v[40:43] offset:6144
v_xor_b32 v47, v107, v47
ds_write_b128 v89, v[44:47] offset:7168
s_waitcnt vmcnt(6)
v_bitop3_b32 v109, v109, v51, v107 bitop3:0xf6
v_bitop3_b32 v109, v109, v55, v107 bitop3:0xf6
v_xor_b32 v51, v107, v51
ds_write_b128 v89, v[48:51] offset:8192
v_xor_b32 v55, v107, v55
ds_write_b128 v89, v[52:55] offset:9216
s_waitcnt vmcnt(4)
v_bitop3_b32 v109, v109, v59, v107 bitop3:0xf6
v_bitop3_b32 v109, v109, v63, v107 bitop3:0xf6
v_xor_b32 v59, v107, v59
ds_write_b128 v89, v[56:59] offset:10240
v_xor_b32 v63, v107, v63
ds_write_b128 v89, v[60:63] offset:11264
s_waitcnt vmcnt(2)
v_bitop3_b32 v109, v109, v67, v107 bitop3:0xf6
v_bitop3_b32 v109, v109, v71, v107 bitop3:0xf6
v_xor_b32 v67, v107, v67
ds_write_b128 v90, v[64:67] offset:12288
v_xor_b32 v71, v107, v71
ds_write_b128 v90, v[68:71] offset:13312
s_waitcnt vmcnt(0)
v_bitop3_b32 v109, v109, v75, v107 bitop3:0xf6
v_bitop3_b32 v109, v109, v79, v107 bitop3:0xf6
v_xor_b32 v75, v107, v75
ds_write_b128 v90, v[72:75] offset:14336
v_xor_b32 v79, v107, v79
ds_write_b128 v90, v[76:79] offset:15360
Lh2_30j:
v_cmp_lt_u32 vcc, s89, v109
s_cbranch_vccz Lh2_30x
s_waitcnt lgkmcnt(0)
v_xor_b32 v19, v107, v19
v_xor_b32 v23, v107, v23
v_xor_b32 v27, v107, v27
v_xor_b32 v31, v107, v31
v_xor_b32 v35, v107, v35
v_xor_b32 v39, v107, v39
v_xor_b32 v43, v107, v43
v_xor_b32 v47, v107, v47
v_xor_b32 v51, v107, v51
v_xor_b32 v55, v107, v55
v_xor_b32 v59, v107, v59
v_xor_b32 v63, v107, v63
v_xor_b32 v67, v107, v67
v_xor_b32 v71, v107, v71
v_xor_b32 v75, v107, v75
v_xor_b32 v79, v107, v79
s_mov_b32 s97, 0xff
s_mov_b32 s98, 0xff
s_bitcmp1_b32 s98, 0
s_cbranch_scc0 Lh2_30uc0
v_bitop3_b32 v109, v19, v23, v107 bitop3:0x7e
v_cmp_lt_u32 vcc, s89, v109
s_cbranch_vccnz Lh2_30uc0
v_and_b32 v19, s89, v19
ds_write_b128 v89, v[16:19] offset:0
v_and_b32 v23, s89, v23
ds_write_b128 v89, v[20:23] offset:1024
s_bitset0_b32 s97, 0
Lh2_30uc0:
s_bitcmp1_b32 s98, 1
s_cbranch_scc0 Lh2_30uc1
v_bitop3_b32 v109, v27, v31, v107 bitop3:0x7e
v_cmp_lt_u32 vcc, s89, v109
s_cbranch_vccnz Lh2_30uc1
v_and_b32 v27, s89, v27
ds_write_b128 v89, v[24:27] offset:2048
v_and_b32 v31, s89, v31
ds_write_b128 v89, v[28:31] offset:3072
s_bitset0_b32 s97, 1
Lh2_30uc1:
s_bitcmp1_b32 s98, 2
s_cbranch_scc0 Lh2_30uc2
v_bitop3_b32 v109, v35, v39, v107 bitop3:0x7e
v_cmp_lt_u32 vcc, s89, v109
s_cbranch_vccnz Lh2_30uc2
v_and_b32 v35, s89, v35
ds_write_b128 v89, v[32:35] offset:4096
v_and_b32 v39, s89, v39
ds_write_b128 v89, v[36:39] offset:5120
s_bitset0_b32 s97, 2
Lh2_30uc2:
s_bitcmp1_b32 s98, 3
s_cbranch_scc0 Lh2_30uc3
v_bitop3_b32 v109, v43, v47, v107 bitop3:0x7e
v_cmp_lt_u32 vcc, s89, v109
s_cbranch_vccnz Lh2_30uc3
v_and_b32 v43, s89, v43
ds_write_b128 v89, v[40:43] offset:6144
v_and_b32 v47, s89, v47
ds_write_b128 v89, v[44:47] offset:7168
s_bitset0_b32 s97, 3
Lh2_30uc3:
s_bitcmp1_b32 s98, 4
s_cbranch_scc0 Lh2_30uc4
v_bitop3_b32 v109, v51, v55, v107 bitop3:0x7e
v_cmp_lt_u32 vcc, s89, v109
s_cbranch_vccnz Lh2_30uc4
v_and_b32 v51, s89, v51
ds_write_b128 v89, v[48:51] offset:8192
v_and_b32 v55, s89, v55
ds_write_b128 v89, v[52:55] offset:9216
s_bitset0_b32 s97, 4
Lh2_30uc4:
s_bitcmp1_b32 s98, 5
s_cbranch_scc0 Lh2_30uc5
v_bitop3_b32 v109, v59, v63, v107 bitop3:0x7e
v_cmp_lt_u32 vcc, s89, v109
s_cbranch_vccnz Lh2_30uc5
v_and_b32 v59, s89, v59
ds_write_b128 v89, v[56:59] offset:10240
v_and_b32 v63, s89, v63
ds_write_b128 v89, v[60:63] offset:11264
s_bitset0_b32 s97, 5
Lh2_30uc5:
s_bitcmp1_b32 s98, 6
s_cbranch_scc0 Lh2_30uc6
v_bitop3_b32 v109, v67, v71, v107 bitop3:0x7e
v_cmp_lt_u32 vcc, s89, v109
s_cbranch_vccnz Lh2_30uc6
v_and_b32 v67, s89, v67
ds_write_b128 v90, v[64:67] offset:12288
v_and_b32 v71, s89, v71
ds_write_b128 v90, v[68:71] offset:13312
s_bitset0_b32 s97, 6
Lh2_30uc6:
s_bitcmp1_b32 s98, 7
s_cbranch_scc0 Lh2_30uc7
v_bitop3_b32 v109, v75, v79, v107 bitop3:0x7e
v_cmp_lt_u32 vcc, s89, v109
s_cbranch_vccnz Lh2_30uc7
v_and_b32 v75, s89, v75
ds_write_b128 v90, v[72:75] offset:14336
v_and_b32 v79, s89, v79
ds_write_b128 v90, v[76:79] offset:15360
s_bitset0_b32 s97, 7
Lh2_30uc7:
Lh2_30r:
s_cmp_eq_u32 s97, 0
s_cbranch_scc1 Lh2_30x
s_sleep 4
s_sub_u32 s78, s78, 8
s_cbranch_scc1 LEND
s_waitcnt vmcnt(0)
s_mov_b32 s98, s97
s_bitcmp1_b32 s98, 0
s_cbranch_scc0 Lh2_30di0
s_add_u32 s84, s95, 0
buffer_load_dwordx4 v[16:19], v9, s[48:51], s84 offen offset:0 sc1
buffer_load_dwordx4 v[20:23], v9, s[48:51], s84 offen offset:1024 sc1
Lh2_30di0:
s_bitcmp1_b32 s98, 1
s_cbranch_scc0 Lh2_30di1
s_add_u32 s84, s95, 0
buffer_load_dwordx4 v[24:27], v9, s[48:51], s84 offen offset:2048 sc1
buffer_load_dwordx4 v[28:31], v9, s[48:51], s84 offen offset:3072 sc1
Lh2_30di1:
s_bitcmp1_b32 s98, 2
s_cbranch_scc0 Lh2_30di2
s_add_u32 s84, s95, 4096
buffer_load_dwordx4 v[32:35], v9, s[48:51], s84 offen offset:0 sc1
buffer_load_dwordx4 v[36:39], v9, s[48:51], s84 offen offset:1024 sc1
Lh2_30di2:
s_bitcmp1_b32 s98, 3
s_cbranch_scc0 Lh2_30di3
s_add_u32 s84, s95, 4096
buffer_load_dwordx4 v[40:43], v9, s[48:51], s84 offen offset:2048 sc1
buffer_load_dwordx4 v[44:47], v9, s[48:51], s84 offen offset:3072 sc1
Lh2_30di3:
s_bitcmp1_b32 s98, 4
s_cbranch_scc0 Lh2_30di4
s_add_u32 s84, s95, 8192
buffer_load_dwordx4 v[48:51], v9, s[48:51], s84 offen offset:0 sc1
buffer_load_dwordx4 v[52:55], v9, s[48:51], s84 offen offset:1024 sc1
Lh2_30di4:
s_bitcmp1_b32 s98, 5
s_cbranch_scc0 Lh2_30di5
s_add_u32 s84, s95, 8192
buffer_load_dwordx4 v[56:59], v9, s[48:51], s84 offen offset:2048 sc1
buffer_load_dwordx4 v[60:63], v9, s[48:51], s84 offen offset:3072 sc1
Lh2_30di5:
s_bitcmp1_b32 s98, 6
s_cbranch_scc0 Lh2_30di6
s_add_u32 s84, s95, 12288
buffer_load_dwordx4 v[64:67], v9, s[48:51], s84 offen offset:0 sc1
buffer_load_dwordx4 v[68:71], v9, s[48:51], s84 offen offset:1024 sc1
Lh2_30di6:
s_bitcmp1_b32 s98, 7
s_cbranch_scc0 Lh2_30di7
s_add_u32 s84, s95, 12288
buffer_load_dwordx4 v[72:75], v9, s[48:51], s84 offen offset:2048 sc1
buffer_load_dwordx4 v[76:79], v9, s[48:51], s84 offen offset:3072 sc1
Lh2_30di7:
s_waitcnt vmcnt(0)
s_bitcmp1_b32 s98, 0
s_cbranch_scc0 Lh2_30ec0
v_bitop3_b32 v109, v19, v23, v107 bitop3:0x7e
v_cmp_lt_u32 vcc, s89, v109
s_cbranch_vccnz Lh2_30ec0
v_and_b32 v19, s89, v19
ds_write_b128 v89, v[16:19] offset:0
v_and_b32 v23, s89, v23
ds_write_b128 v89, v[20:23] offset:1024
s_bitset0_b32 s97, 0
Lh2_30ec0:
s_bitcmp1_b32 s98, 1
s_cbranch_scc0 Lh2_30ec1
v_bitop3_b32 v109, v27, v31, v107 bitop3:0x7e
v_cmp_lt_u32 vcc, s89, v109
s_cbranch_vccnz Lh2_30ec1
v_and_b32 v27, s89, v27
ds_write_b128 v89, v[24:27] offset:2048
v_and_b32 v31, s89, v31
ds_write_b128 v89, v[28:31] offset:3072
s_bitset0_b32 s97, 1
Lh2_30ec1:
s_bitcmp1_b32 s98, 2
s_cbranch_scc0 Lh2_30ec2
v_bitop3_b32 v109, v35, v39, v107 bitop3:0x7e
v_cmp_lt_u32 vcc, s89, v109
s_cbranch_vccnz Lh2_30ec2
v_and_b32 v35, s89, v35
ds_write_b128 v89, v[32:35] offset:4096
v_and_b32 v39, s89, v39
ds_write_b128 v89, v[36:39] offset:5120
s_bitset0_b32 s97, 2
Lh2_30ec2:
s_bitcmp1_b32 s98, 3
s_cbranch_scc0 Lh2_30ec3
v_bitop3_b32 v109, v43, v47, v107 bitop3:0x7e
v_cmp_lt_u32 vcc, s89, v109
s_cbranch_vccnz Lh2_30ec3
v_and_b32 v43, s89, v43
ds_write_b128 v89, v[40:43] offset:6144
v_and_b32 v47, s89, v47
ds_write_b128 v89, v[44:47] offset:7168
s_bitset0_b32 s97, 3
Lh2_30ec3:
s_bitcmp1_b32 s98, 4
s_cbranch_scc0 Lh2_30ec4
v_bitop3_b32 v109, v51, v55, v107 bitop3:0x7e
v_cmp_lt_u32 vcc, s89, v109
s_cbranch_vccnz Lh2_30ec4
v_and_b32 v51, s89, v51
ds_write_b128 v89, v[48:51] offset:8192
v_and_b32 v55, s89, v55
ds_write_b128 v89, v[52:55] offset:9216
s_bitset0_b32 s97, 4
Lh2_30ec4:
s_bitcmp1_b32 s98, 5
s_cbranch_scc0 Lh2_30ec5
v_bitop3_b32 v109, v59, v63, v107 bitop3:0x7e
v_cmp_lt_u32 vcc, s89, v109
s_cbranch_vccnz Lh2_30ec5
v_and_b32 v59, s89, v59
ds_write_b128 v89, v[56:59] offset:10240
v_and_b32 v63, s89, v63
ds_write_b128 v89, v[60:63] offset:11264
s_bitset0_b32 s97, 5
Lh2_30ec5:
s_bitcmp1_b32 s98, 6
s_cbranch_scc0 Lh2_30ec6
v_bitop3_b32 v109, v67, v71, v107 bitop3:0x7e
v_cmp_lt_u32 vcc, s89, v109
s_cbranch_vccnz Lh2_30ec6
v_and_b32 v67, s89, v67
ds_write_b128 v90, v[64:67] offset:12288
v_and_b32 v71, s89, v71
ds_write_b128 v90, v[68:71] offset:13312
s_bitset0_b32 s97, 6
Lh2_30ec6:
s_bitcmp1_b32 s98, 7
s_cbranch_scc0 Lh2_30ec7
v_bitop3_b32 v109, v75, v79, v107 bitop3:0x7e
v_cmp_lt_u32 vcc, s89, v109
s_cbranch_vccnz Lh2_30ec7
v_and_b32 v75, s89, v75
ds_write_b128 v90, v[72:75] offset:14336
v_and_b32 v79, s89, v79
ds_write_b128 v90, v[76:79] offset:15360
s_bitset0_b32 s97, 7
Lh2_30ec7:
s_branch Lh2_30r
Lh2_30x:
s_waitcnt lgkmcnt(0)
s_mov_b64 exec, 1
ds_add_u32 v10, v11 offset:8
s_mov_b64 exec, -1
Lw_33:
ds_read_b32 v12, v10 offset:8
s_sub_u32 s78, s78, 1
s_cbranch_scc1 LEND
s_waitcnt lgkmcnt(0)
v_readfirstlane_b32 s80, v12
s_nop 0
s_cmp_ge_u32 s80, 4
s_cbranch_scc0 Lw_33
ds_read_b128 v[48:51], v91 offset:0
ds_read_b128 v[52:55], v91 offset:1024
ds_read_b128 v[56:59], v91 offset:2048
ds_read_b128 v[60:63], v91 offset:3072
ds_read_b128 v[64:67], v91 offset:4096
ds_read_b128 v[68:71], v91 offset:5120
ds_read_b128 v[72:75], v91 offset:6144
ds_read_b128 v[76:79], v91 offset:7168
s_waitcnt lgkmcnt(7)
v_mfma_f32_32x32x16_bf16 v[16:31], v[128:131], v[48:51], 0
ds_read_b128 v[48:51], v91 offset:8192
s_waitcnt lgkmcnt(7)
v_mfma_f32_32x32x16_bf16 v[16:31], v[132:135], v[52:55], v[16:31]
ds_read_b128 v[52:55], v91 offset:9216
s_waitcnt lgkmcnt(7)
v_mfma_f32_32x32x16_bf16 v[16:31], v[136:139], v[56:59], v[16:31]
ds_read_b128 v[56:59], v91 offset:10240
s_waitcnt lgkmcnt(7)
v_mfma_f32_32x32x16_bf16 v[16:31], v[140:143], v[60:63], v[16:31]
ds_read_b128 v[60:63], v91 offset:11264
s_waitcnt lgkmcnt(7)
v_mfma_f32_32x32x16_bf16 v[16:31], v[144:147], v[64:67], v[16:31]
ds_read_b128 v[64:67], v91 offset:12288
s_waitcnt lgkmcnt(7)
v_mfma_f32_32x32x16_bf16 v[16:31], v[148:151], v[68:71], v[16:31]
ds_read_b128 v[68:71], v91 offset:13312
s_waitcnt lgkmcnt(7)
v_mfma_f32_32x32x16_bf16 v[16:31], v[152:155], v[72:75], v[16:31]
ds_read_b128 v[72:75], v91 offset:14336
s_waitcnt lgkmcnt(7)
v_mfma_f32_32x32x16_bf16 v[16:31], v[156:159], v[76:79], v[16:31]
ds_read_b128 v[76:79], v91 offset:15360
s_waitcnt lgkmcnt(7)
v_mfma_f32_32x32x16_bf16 v[16:31], v[160:163], v[48:51], v[16:31]
ds_read_b128 v[48:51], v91 offset:16384
s_waitcnt lgkmcnt(7)
v_mfma_f32_32x32x16_bf16 v[16:31], v[164:167], v[52:55], v[16:31]
ds_read_b128 v[52:55], v91 offset:17408
s_waitcnt lgkmcnt(7)
v_mfma_f32_32x32x16_bf16 v[16:31], v[168:171], v[56:59], v[16:31]
ds_read_b128 v[56:59], v91 offset:18432
s_waitcnt lgkmcnt(7)
v_mfma_f32_32x32x16_bf16 v[16:31], v[172:175], v[60:63], v[16:31]
ds_read_b128 v[60:63], v91 offset:19456
s_waitcnt lgkmcnt(7)
v_mfma_f32_32x32x16_bf16 v[16:31], v[176:179], v[64:67], v[16:31]
ds_read_b128 v[64:67], v91 offset:20480
s_waitcnt lgkmcnt(7)
v_mfma_f32_32x32x16_bf16 v[16:31], v[180:183], v[68:71], v[16:31]
ds_read_b128 v[68:71], v91 offset:21504
s_waitcnt lgkmcnt(7)
v_mfma_f32_32x32x16_bf16 v[16:31], v[184:187], v[72:75], v[16:31]
ds_read_b128 v[72:75], v91 offset:22528
s_waitcnt lgkmcnt(7)
v_mfma_f32_32x32x16_bf16 v[16:31], v[188:191], v[76:79], v[16:31]
ds_read_b128 v[76:79], v91 offset:23552
s_waitcnt lgkmcnt(7)
v_mfma_f32_32x32x16_bf16 v[16:31], v[192:195], v[48:51], v[16:31]
ds_read_b128 v[48:51], v91 offset:24576
s_waitcnt lgkmcnt(7)
v_mfma_f32_32x32x16_bf16 v[16:31], v[196:199], v[52:55], v[16:31]
ds_read_b128 v[52:55], v91 offset:25600
s_waitcnt lgkmcnt(7)
v_mfma_f32_32x32x16_bf16 v[16:31], v[200:203], v[56:59], v[16:31]
ds_read_b128 v[56:59], v91 offset:26624
s_waitcnt lgkmcnt(7)
v_mfma_f32_32x32x16_bf16 v[16:31], v[204:207], v[60:63], v[16:31]
ds_read_b128 v[60:63], v91 offset:27648
s_waitcnt lgkmcnt(7)
v_mfma_f32_32x32x16_bf16 v[16:31], v[208:211], v[64:67], v[16:31]
ds_read_b128 v[64:67], v92 offset:28672
s_waitcnt lgkmcnt(7)
v_mfma_f32_32x32x16_bf16 v[16:31], v[212:215], v[68:71], v[16:31]
ds_read_b128 v[68:71], v92 offset:29696
s_waitcnt lgkmcnt(7)
v_mfma_f32_32x32x16_bf16 v[16:31], v[216:219], v[72:75], v[16:31]
ds_read_b128 v[72:75], v92 offset:30720
s_waitcnt lgkmcnt(7)
v_mfma_f32_32x32x16_bf16 v[16:31], v[220:223], v[76:79], v[16:31]
ds_read_b128 v[76:79], v92 offset:31744
s_waitcnt lgkmcnt(7)
v_mfma_f32_32x32x16_bf16 v[16:31], v[224:227], v[48:51], v[16:31]
s_waitcnt lgkmcnt(6)
v_mfma_f32_32x32x16_bf16 v[16:31], v[228:231], v[52:55], v[16:31]
s_waitcnt lgkmcnt(5)
v_mfma_f32_32x32x16_bf16 v[16:31], v[232:235], v[56:59], v[16:31]
s_waitcnt lgkmcnt(4)
v_mfma_f32_32x32x16_bf16 v[16:31], v[236:239], v[60:63], v[16:31]
s_waitcnt lgkmcnt(3)
v_mfma_f32_32x32x16_bf16 v[16:31], v[240:243], v[64:67], v[16:31]
s_waitcnt lgkmcnt(2)
v_mfma_f32_32x32x16_bf16 v[16:31], v[244:247], v[68:71], v[16:31]
s_waitcnt lgkmcnt(1)
v_mfma_f32_32x32x16_bf16 v[16:31], v[248:251], v[72:75], v[16:31]
s_waitcnt lgkmcnt(0)
v_mfma_f32_32x32x16_bf16 v[16:31], v[252:255], v[76:79], v[16:31]
s_nop 11
v_cvt_pk_bf16_f32 v32, v16, v17
v_cvt_pk_bf16_f32 v33, v18, v19
v_cvt_pk_bf16_f32 v34, v20, v21
v_cvt_pk_bf16_f32 v35, v22, v23
v_cvt_pk_bf16_f32 v36, v24, v25
v_cvt_pk_bf16_f32 v37, v26, v27
v_cvt_pk_bf16_f32 v38, v28, v29
v_cvt_pk_bf16_f32 v39, v30, v31
v_permlane32_swap_b32 v32, v34
v_permlane32_swap_b32 v33, v35
v_permlane32_swap_b32 v36, v38
v_permlane32_swap_b32 v37, v39
buffer_store_dwordx4 v[32:35], v88, s[52:55], s96 offen
buffer_store_dwordx4 v[36:39], v88, s[52:55], s96 offen offset:32
LBX:
LEND:
s_endpgm

.p2align 8
LTAB:
.long 0x3f803f80,0x3f803f80,0x3f803f80,0x3f803f80,0xbf803f80,0xbf803f80,0xbf803f80,0xbf803f80
.long 0x3f7b3f80,0x3f553f6d,0xbe480000,0xbf0ebec4,0xbe480000,0xbf0ebec4,0xbf7bbf80,0xbf55bf6d
.long 0x3f6d3f80,0x3ec43f35,0xbf6dbf80,0xbec4bf35,0xbec40000,0xbf6dbf35,0x3ec40000,0x3f6d3f35
.long 0x3f553f80,0xbe483ec4,0x3f0e0000,0x3f7b3f6d,0xbf0e0000,0xbf7bbf6d,0x3f553f80,0xbe483ec4
.long 0x3f353f80,0xbf350000,0x3f353f80,0xbf350000,0xbf350000,0xbf35bf80,0xbf350000,0xbf35bf80
.long 0x3f0e3f80,0xbf7bbec4,0xbf550000,0xbe48bf6d,0xbf550000,0xbe48bf6d,0xbf0ebf80,0x3f7b3ec4
.long 0x3ec43f80,0xbf6dbf35,0xbec4bf80,0x3f6d3f35,0xbf6d0000,0x3ec4bf35,0x3f6d0000,0xbec43f35
.long 0x3e483f80,0xbf0ebf6d,0x3f7b0000,0xbf553ec4,0xbf7b0000,0x3f55bec4,0x3e483f80,0xbf0ebf6d
.long 0x3f80,0xbf80,0x3f80,0xbf80,0xbf800000,0x3f800000,0xbf800000,0x3f800000
.long 0xbe483f80,0x3f0ebf6d,0xbf7b0000,0x3f553ec4,0xbf7b0000,0x3f553ec4,0x3e48bf80,0xbf0e3f6d
.long 0xbec43f80,0x3f6dbf35,0x3ec4bf80,0xbf6d3f35,0xbf6d0000,0x3ec43f35,0x3f6d0000,0xbec4bf35
.long 0xbf0e3f80,0x3f7bbec4,0x3f550000,0x3e48bf6d,0xbf550000,0xbe483f6d,0xbf0e3f80,0x3f7bbec4
.long 0xbf353f80,0x3f350000,0xbf353f80,0x3f350000,0xbf350000,0xbf353f80,0xbf350000,0xbf353f80
.long 0xbf553f80,0x3e483ec4,0xbf0e0000,0xbf7b3f6d,0xbf0e0000,0xbf7b3f6d,0x3f55bf80,0xbe48bec4
.long 0xbf6d3f80,0xbec43f35,0x3f6dbf80,0x3ec4bf35,0xbec40000,0xbf6d3f35,0x3ec40000,0x3f6dbf35
.long 0xbf7b3f80,0xbf553f6d,0x3e480000,0x3f0ebec4,0xbe480000,0xbf0e3ec4,0xbf7b3f80,0xbf553f6d
.long 0x3f803f80,0x3f803f80,0x3f803f80,0x3f803f80,0xbf803f80,0xbf803f80,0xbf803f80,0xbf803f80
.long 0x3f0e3f35,0x3e483ec4,0xbf55bf35,0xbf7bbf6d,0xbf55bf35,0xbf7bbf6d,0xbf0ebf35,0xbe48bec4
.long 0xbec40000,0xbf6dbf35,0x3ec40000,0x3f6d3f35,0xbf6dbf80,0xbec4bf35,0x3f6d3f80,0x3ec43f35
.long 0xbf7bbf35,0xbf0ebf6d,0x3e483f35,0xbf55bec4,0xbe48bf35,0x3f553ec4,0xbf7bbf35,0xbf0ebf6d
.long 0xbf35bf80,0x3f350000,0xbf35bf80,0x3f350000,0x3f350000,0x3f353f80,0x3f350000,0x3f353f80
.long 0x3e48bf35,0x3f553f6d,0x3f7b3f35,0xbf0e3ec4,0x3f7b3f35,0xbf0e3ec4,0xbe483f35,0xbf55bf6d
.long 0x3f6d0000,0xbec43f35,0xbf6d0000,0x3ec4bf35,0x3ec43f80,0xbf6dbf35,0xbec4bf80,0x3f6d3f35
.long 0x3f553f35,0xbf7bbec4,0x3f0ebf35,0xbe483f6d,0xbf0e3f35,0x3e48bf6d,0x3f553f35,0xbf7bbec4
.long 0x3f80,0xbf80,0x3f80,0xbf80,0xbf800000,0x3f800000,0xbf800000,0x3f800000
.long 0xbf553f35,0x3f7bbec4,0xbf0ebf35,0x3e483f6d,0xbf0ebf35,0x3e483f6d,0x3f55bf35,0xbf7b3ec4
.long 0xbf6d0000,0x3ec43f35,0x3f6d0000,0xbec4bf35,0x3ec4bf80,0xbf6d3f35,0xbec43f80,0x3f6dbf35
.long 0xbe48bf35,0xbf553f6d,0xbf7b3f35,0x3f0e3ec4,0x3f7bbf35,0xbf0ebec4,0xbe48bf35,0xbf553f6d
.long 0x3f35bf80,0xbf350000,0x3f35bf80,0xbf350000,0x3f350000,0x3f35bf80,0x3f350000,0x3f35bf80
.long 0x3f7bbf35,0x3f0ebf6d,0xbe483f35,0x3f55bec4,0xbe483f35,0x3f55bec4,0xbf7b3f35,0xbf0e3f6d
.long 0x3ec40000,0x3f6dbf35,0xbec40000,0xbf6d3f35,0xbf6d3f80,0xbec43f35,0x3f6dbf80,0x3ec4bf35
.long 0xbf0e3f35,0xbe483ec4,0x3f55bf35,0x3f7bbf6d,0xbf553f35,0xbf7b3f6d,0xbf0e3f35,0xbe483ec4
.long 0x3f803f80,0x3f803f80,0x3f803f80,0x3f803f80,0xbf803f80,0xbf803f80,0xbf803f80,0xbf803f80
.long 0xbf7bbf80,0xbf55bf6d,0x3e480000,0x3f0e3ec4,0x3e480000,0x3f0e3ec4,0x3f7b3f80,0x3f553f6d
.long 0x3f6d3f80,0x3ec43f35,0xbf6dbf80,0xbec4bf35,0xbec40000,0xbf6dbf35,0x3ec40000,0x3f6d3f35
.long 0xbf55bf80,0x3e48bec4,0xbf0e0000,0xbf7bbf6d,0x3f0e0000,0x3f7b3f6d,0xbf55bf80,0x3e48bec4
.long 0x3f353f80,0xbf350000,0x3f353f80,0xbf350000,0xbf350000,0xbf35bf80,0xbf350000,0xbf35bf80
.long 0xbf0ebf80,0x3f7b3ec4,0x3f550000,0x3e483f6d,0x3f550000,0x3e483f6d,0x3f0e3f80,0xbf7bbec4
.long 0x3ec43f80,0xbf6dbf35,0xbec4bf80,0x3f6d3f35,0xbf6d0000,0x3ec4bf35,0x3f6d0000,0xbec43f35
.long 0xbe48bf80,0x3f0e3f6d,0xbf7b0000,0x3f55bec4,0x3f7b0000,0xbf553ec4,0xbe48bf80,0x3f0e3f6d
.long 0x3f80,0xbf80,0x3f80,0xbf80,0xbf800000,0x3f800000,0xbf800000,0x3f800000
.long 0x3e48bf80,0xbf0e3f6d,0x3f7b0000,0xbf55bec4,0x3f7b0000,0xbf55bec4,0xbe483f80,0x3f0ebf6d
.long 0xbec43f80,0x3f6dbf35,0x3ec4bf80,0xbf6d3f35,0xbf6d0000,0x3ec43f35,0x3f6d0000,0xbec4bf35
.long 0x3f0ebf80,0xbf7b3ec4,0xbf550000,0xbe483f6d,0x3f550000,0x3e48bf6d,0x3f0ebf80,0xbf7b3ec4
.long 0xbf353f80,0x3f350000,0xbf353f80,0x3f350000,0xbf350000,0xbf353f80,0xbf350000,0xbf353f80
.long 0x3f55bf80,0xbe48bec4,0x3f0e0000,0x3f7bbf6d,0x3f0e0000,0x3f7bbf6d,0xbf553f80,0x3e483ec4
.long 0xbf6d3f80,0xbec43f35,0x3f6dbf80,0x3ec4bf35,0xbec40000,0xbf6d3f35,0x3ec40000,0x3f6dbf35
.long 0x3f7bbf80,0x3f55bf6d,0xbe480000,0xbf0e3ec4,0x3e480000,0x3f0ebec4,0x3f7bbf80,0x3f55bf6d
.long 0x3f803f80,0x3f803f80,0x3f803f80,0x3f803f80,0xbf803f80,0xbf803f80,0xbf803f80,0xbf803f80
.long 0xbf0ebf35,0xbe48bec4,0x3f553f35,0x3f7b3f6d,0x3f553f35,0x3f7b3f6d,0x3f0e3f35,0x3e483ec4
.long 0xbec40000,0xbf6dbf35,0x3ec40000,0x3f6d3f35,0xbf6dbf80,0xbec4bf35,0x3f6d3f80,0x3ec43f35
.long 0x3f7b3f35,0x3f0e3f6d,0xbe48bf35,0x3f553ec4,0x3e483f35,0xbf55bec4,0x3f7b3f35,0x3f0e3f6d
.long 0xbf35bf80,0x3f350000,0xbf35bf80,0x3f350000,0x3f350000,0x3f353f80,0x3f350000,0x3f353f80
.long 0xbe483f35,0xbf55bf6d,0xbf7bbf35,0x3f0ebec4,0xbf7bbf35,0x3f0ebec4,0x3e48bf35,0x3f553f6d
.long 0x3f6d0000,0xbec43f35,0xbf6d0000,0x3ec4bf35,0x3ec43f80,0xbf6dbf35,0xbec4bf80,0x3f6d3f35
.long 0xbf55bf35,0x3f7b3ec4,0xbf0e3f35,0x3e48bf6d,0x3f0ebf35,0xbe483f6d,0xbf55bf35,0x3f7b3ec4
.long 0x3f80,0xbf80,0x3f80,0xbf80,0xbf800000,0x3f800000,0xbf800000,0x3f800000
.long 0x3f55bf35,0xbf7b3ec4,0x3f0e3f35,0xbe48bf6d,0x3f0e3f35,0xbe48bf6d,0xbf553f35,0x3f7bbec4
.long 0xbf6d0000,0x3ec43f35,0x3f6d0000,0xbec4bf35,0x3ec4bf80,0xbf6d3f35,0xbec43f80,0x3f6dbf35
.long 0x3e483f35,0x3f55bf6d,0x3f7bbf35,0xbf0ebec4,0xbf7b3f35,0x3f0e3ec4,0x3e483f35,0x3f55bf6d
.long 0x3f35bf80,0xbf350000,0x3f35bf80,0xbf350000,0x3f350000,0x3f35bf80,0x3f350000,0x3f35bf80
.long 0xbf7b3f35,0xbf0e3f6d,0x3e48bf35,0xbf553ec4,0x3e48bf35,0xbf553ec4,0x3f7bbf35,0x3f0ebf6d
.long 0x3ec40000,0x3f6dbf35,0xbec40000,0xbf6d3f35,0xbf6d3f80,0xbec43f35,0x3f6dbf80,0x3ec4bf35
.long 0x3f0ebf35,0x3e48bec4,0xbf553f35,0xbf7b3f6d,0x3f55bf35,0x3f7bbf6d,0x3f0ebf35,0x3e48bec4

.section .rodata,"a"
.p2align 6
.amdhsa_kernel concat_heads__spectral_fnet__linear_kernel_hedgehog__prompt_kernel
  .amdhsa_next_free_vgpr 256
  .amdhsa_next_free_sgpr 102
  .amdhsa_accum_offset 256
  .amdhsa_group_segment_fixed_size 0
  .amdhsa_kernarg_size 96
  .amdhsa_user_sgpr_count 2
  .amdhsa_user_sgpr_kernarg_segment_ptr 1
  .amdhsa_system_sgpr_workgroup_id_x 1
  .amdhsa_float_denorm_mode_32 3
.end_amdhsa_kernel
```
